```python
import torch

def _softmax(x, axis=-1):
    return torch.softmax(x, dim=axis)
def _gelu(x):
    return torch.nn.functional.gelu(x, approximate="tanh")
def _silu(x):
    return torch.nn.functional.silu(x)
def _sigmoid(x):
    return torch.sigmoid(x)
def _layernorm(x, axis=-1, eps=1e-5):
    m = x.mean(dim=axis, keepdim=True)
    v = x.var(dim=axis, keepdim=True, unbiased=False)
    return (x - m) / torch.sqrt(v + eps)
def _scatter_add(tgt, idx, src, axis=0):
    return tgt.clone().index_add_(axis, idx, src)
def _segment_sum(src, seg, n):
    out = torch.zeros((n,) + src.shape[1:], dtype=src.dtype)
    return out.index_add_(0, seg, src)
def _pad(x, pw):
    flat = tuple(v for pair in reversed(pw) for v in pair)
    return torch.nn.functional.pad(x, flat)

kernel_name = 'standalone__self_sup_conv_stem_hubert__speech'

def setup_inputs():

    _w = (lambda a: (lambda t: t.to(torch.bfloat16) if t.is_floating_point() else t)(torch.as_tensor(a)))
    B, T, D, K = 2, 4000, 512, 3
    scale = (1.0 / (K * D)) ** 0.5
    return {
        "x": _w((lambda *s: torch.randn(*s, dtype=torch.bfloat16) * 0.05)(B, T, D)),
        "w": _w((lambda *s: torch.randn(*s, dtype=torch.bfloat16) * 0.05)(K, D, D) * scale),
        "b": _w((lambda *s: torch.randn(*s, dtype=torch.bfloat16) * 0.05)(D) * 0.1),
        "gamma": _w(torch.ones((D,), dtype=float)),
        "beta": _w(torch.zeros((D,), dtype=float)),
    }

def reference(x, w, b, gamma, beta):
    B, T, D = x.shape
    K = w.shape[0]
    s = 2
    L = (T - K) // s + 1
    y = torch.einsum('blc,cd->bld', x[:, 0 : s * L : s, :], w[0])
    for i in range(1, K):
        y = y + torch.einsum('blc,cd->bld', x[:, i : i + s * L : s, :], w[i])
    y = y + b[None, None, :]
    mu = y.mean(1, keepdims=True)
    var = ((y - mu) ** 2).mean(1, keepdims=True)
    yn = (y - mu) / torch.sqrt(var + 1e-5)
    yn = yn * gamma[None, None, :] + beta[None, None, :]
    return _gelu(yn)
```

```asm
; @launch kernel=conv_gemm_kernel grid=(256,1,1) block=(256,1,1) lds=147456
; @launch kernel=norm_gelu_kernel grid=(256,1,1) block=(256,1,1) lds=1024
.amdgcn_target "amdgcn-amd-amdhsa--gfx950"
.text
.globl conv_gemm_kernel
.p2align 8
.type conv_gemm_kernel,@function
conv_gemm_kernel:
    s_cmp_ge_u32 s2, 256
    s_cbranch_scc1 L_k1_end
    s_load_dwordx4 s[24:27], s[0:1], 0
    s_load_dwordx2 s[28:29], s[0:1], 16
    s_load_dwordx2 s[30:31], s[0:1], 56
    s_and_b32 s20, s2, 31
    s_lshr_b32 s21, s2, 5
    s_lshr_b32 s22, s20, 4
    s_and_b32 s23, s20, 15
    v_and_b32 v1, 63, v0
    v_lshrrev_b32 v2, 6, v0
    s_nop 0
    v_readfirstlane_b32 s32, v2
    v_lshrrev_b32 v3, 3, v1
    v_lshlrev_b32 v8, 5, v2
    v_add_u32 v3, v3, v8
    v_and_b32 v9, 7, v1
    v_lshrrev_b32 v10, 4, v1
    v_add_u32 v11, 0, v10
    v_and_b32 v11, 7, v11
    v_xor_b32 v11, v11, v9
    v_lshlrev_b32 v11, 4, v11
    v_add_u32 v12, 0, v3
    v_lshl_add_u32 v4, v12, 11, v11
    v_add_u32 v11, 4, v10
    v_and_b32 v11, 7, v11
    v_xor_b32 v11, v11, v9
    v_lshlrev_b32 v11, 4, v11
    v_add_u32 v12, 8, v3
    v_lshl_add_u32 v5, v12, 11, v11
    v_add_u32 v11, 8, v10
    v_and_b32 v11, 7, v11
    v_xor_b32 v11, v11, v9
    v_lshlrev_b32 v11, 4, v11
    v_add_u32 v12, 16, v3
    v_lshl_add_u32 v6, v12, 11, v11
    v_add_u32 v11, 12, v10
    v_and_b32 v11, 7, v11
    v_xor_b32 v11, v11, v9
    v_lshlrev_b32 v11, 4, v11
    v_add_u32 v12, 24, v3
    v_lshl_add_u32 v7, v12, 11, v11
    v_lshrrev_b32 v3, 3, v1
    v_lshlrev_b32 v8, 4, v2
    v_add_u32 v3, v3, v8
    v_lshrrev_b32 v11, 1, v3
    v_and_b32 v11, 1, v11
    v_lshlrev_b32 v11, 2, v11
    v_xor_b32 v11, v11, v9
    v_lshlrev_b32 v11, 4, v11
    s_lshl_b32 s33, s21, 7
    v_add_u32 v11, s33, v11
    v_lshl_add_u32 v14, v3, 10, v11
    v_add_u32 v15, 0x2000, v14
    v_and_b32 v8, 31, v1
    v_lshrrev_b32 v9, 5, v1
    v_lshrrev_b32 v10, 1, v8
    v_and_b32 v10, 7, v10
    v_lshlrev_b32 v11, 5, v2
    v_add_u32 v11, v11, v8
    v_lshlrev_b32 v11, 7, v11
    v_add_u32 v12, 0, v9
    v_xor_b32 v12, v12, v10
    v_lshl_add_u32 v16, v12, 4, v11
    v_add_u32 v12, 2, v9
    v_xor_b32 v12, v12, v10
    v_lshl_add_u32 v17, v12, 4, v11
    v_add_u32 v12, 4, v9
    v_xor_b32 v12, v12, v10
    v_lshl_add_u32 v18, v12, 4, v11
    v_add_u32 v12, 6, v9
    v_xor_b32 v12, v12, v10
    v_lshl_add_u32 v19, v12, 4, v11
    v_lshrrev_b32 v8, 4, v1
    v_lshrrev_b32 v9, 1, v8
    v_and_b32 v8, 1, v8
    v_lshrrev_b32 v10, 2, v1
    v_and_b32 v10, 3, v10
    v_and_b32 v12, 3, v1
    v_lshl_add_u32 v9, v9, 3, v10
    v_lshlrev_b32 v9, 7, v9
    v_add_u32 v9, 0x4000, v9
    v_and_b32 v13, 1, v12
    v_lshl_add_u32 v9, v13, 3, v9
    v_lshrrev_b32 v12, 1, v12
    v_lshl_add_u32 v12, v8, 1, v12
    v_lshrrev_b32 v13, 1, v10
    v_and_b32 v13, 1, v13
    v_lshlrev_b32 v13, 2, v13
    v_xor_b32 v12, v12, v13
    v_lshl_add_u32 v20, v12, 4, v9
    v_xor_b32 v12, 4, v12
    v_lshl_add_u32 v21, v12, 4, v9
    s_waitcnt lgkmcnt(0)
    s_mov_b32 s4, s24
    s_and_b32 s5, s25, 0xffff
    s_mov_b32 s6, 8192000
    s_mov_b32 s7, 0x00020000
    s_mov_b32 s8, s26
    s_and_b32 s9, s27, 0xffff
    s_mov_b32 s10, 1572864
    s_mov_b32 s11, 0x00020000
    s_mov_b32 s12, s30
    s_and_b32 s13, s31, 0xffff
    s_mov_b32 s14, 268435456
    s_mov_b32 s15, 0x00020000
    s_mov_b32 s16, s28
    s_and_b32 s17, s29, 0xffff
    s_mov_b32 s18, 1024
    s_mov_b32 s19, 0x00020000
    s_mul_i32 s34, s22, 4000
    s_lshl_b32 s35, s23, 8
    s_add_u32 s34, s34, s35
    s_lshl_b32 s34, s34, 10
    s_mov_b32 s35, 0
    s_mov_b32 s43, s34
    s_lshr_b32 s42, s2, 3
    s_and_b32 s42, s42, 7
    s_lshr_b32 s40, s2, 3
    s_cmp_ge_u32 s40, 24
    s_cselect_b32 s41, 24, 0
    s_sub_u32 s40, s40, s41
    s_lshl_b32 s35, s40, 16
    s_lshl_b32 s41, s40, 7
    s_add_u32 s34, s34, s41
    s_lshl_b32 s36, s32, 12
    s_lshl_b32 s37, s32, 11
    s_add_u32 s37, s37, 0x4000
    v_mov_b32 v64, 0
    v_mov_b32 v65, 0
    v_mov_b32 v66, 0
    v_mov_b32 v67, 0
    v_mov_b32 v68, 0
    v_mov_b32 v69, 0
    v_mov_b32 v70, 0
    v_mov_b32 v71, 0
    v_mov_b32 v72, 0
    v_mov_b32 v73, 0
    v_mov_b32 v74, 0
    v_mov_b32 v75, 0
    v_mov_b32 v76, 0
    v_mov_b32 v77, 0
    v_mov_b32 v78, 0
    v_mov_b32 v79, 0
    v_mov_b32 v80, 0
    v_mov_b32 v81, 0
    v_mov_b32 v82, 0
    v_mov_b32 v83, 0
    v_mov_b32 v84, 0
    v_mov_b32 v85, 0
    v_mov_b32 v86, 0
    v_mov_b32 v87, 0
    v_mov_b32 v88, 0
    v_mov_b32 v89, 0
    v_mov_b32 v90, 0
    v_mov_b32 v91, 0
    v_mov_b32 v92, 0
    v_mov_b32 v93, 0
    v_mov_b32 v94, 0
    v_mov_b32 v95, 0
    s_lshl_b32 s41, s42, 7
    s_add_u32 s34, s43, s41
    s_lshl_b32 s35, s42, 16
    s_add_u32 m0, s36, 0
    s_nop 0
    buffer_load_dwordx4 v4, s[4:7], s34 offen lds
    s_add_u32 m0, s36, 1024
    s_nop 0
    buffer_load_dwordx4 v5, s[4:7], s34 offen lds
    s_add_u32 m0, s36, 2048
    s_nop 0
    buffer_load_dwordx4 v6, s[4:7], s34 offen lds
    s_add_u32 m0, s36, 3072
    s_nop 0
    buffer_load_dwordx4 v7, s[4:7], s34 offen lds
    s_add_u32 m0, s37, 0
    s_nop 0
    buffer_load_dwordx4 v14, s[8:11], s35 offen lds
    s_add_u32 m0, s37, 1024
    s_nop 0
    buffer_load_dwordx4 v15, s[8:11], s35 offen lds
    s_add_u32 s34, s34, 128
    s_add_u32 s35, s35, 0x10000
    s_cmp_eq_u32 s35, 0x180000
    s_cselect_b32 s41, 3072, 0
    s_cselect_b32 s35, 0, s35
    s_sub_u32 s34, s34, s41
    s_lshl_b32 s41, s42, 7
    s_add_u32 s34, s43, s41
    s_add_u32 s34, s34, 2048
    s_lshl_b32 s35, s42, 16
    s_add_u32 s35, s35, 1048576
    s_add_u32 m0, s36, 24576
    s_nop 0
    buffer_load_dwordx4 v4, s[4:7], s34 offen lds
    s_add_u32 m0, s36, 25600
    s_nop 0
    buffer_load_dwordx4 v5, s[4:7], s34 offen lds
    s_add_u32 m0, s36, 26624
    s_nop 0
    buffer_load_dwordx4 v6, s[4:7], s34 offen lds
    s_add_u32 m0, s36, 27648
    s_nop 0
    buffer_load_dwordx4 v7, s[4:7], s34 offen lds
    s_add_u32 m0, s37, 24576
    s_nop 0
    buffer_load_dwordx4 v14, s[8:11], s35 offen lds
    s_add_u32 m0, s37, 25600
    s_nop 0
    buffer_load_dwordx4 v15, s[8:11], s35 offen lds
    s_add_u32 s34, s34, 128
    s_add_u32 s35, s35, 0x10000
    s_cmp_eq_u32 s35, 0x180000
    s_cselect_b32 s41, 3072, 0
    s_cselect_b32 s35, 0, s35
    s_sub_u32 s34, s34, s41
    s_lshl_b32 s41, s42, 7
    s_add_u32 s34, s43, s41
    s_add_u32 s34, s34, 1024
    s_lshl_b32 s35, s42, 16
    s_add_u32 s35, s35, 524288
    s_add_u32 s42, s42, 1
    s_and_b32 s42, s42, 7
    s_add_u32 m0, s36, 49152
    s_nop 0
    buffer_load_dwordx4 v4, s[4:7], s34 offen lds
    s_add_u32 m0, s36, 50176
    s_nop 0
    buffer_load_dwordx4 v5, s[4:7], s34 offen lds
    s_add_u32 m0, s36, 51200
    s_nop 0
    buffer_load_dwordx4 v6, s[4:7], s34 offen lds
    s_add_u32 m0, s36, 52224
    s_nop 0
    buffer_load_dwordx4 v7, s[4:7], s34 offen lds
    s_add_u32 m0, s37, 49152
    s_nop 0
    buffer_load_dwordx4 v14, s[8:11], s35 offen lds
    s_add_u32 m0, s37, 50176
    s_nop 0
    buffer_load_dwordx4 v15, s[8:11], s35 offen lds
    s_add_u32 s34, s34, 128
    s_add_u32 s35, s35, 0x10000
    s_cmp_eq_u32 s35, 0x180000
    s_cselect_b32 s41, 3072, 0
    s_cselect_b32 s35, 0, s35
    s_sub_u32 s34, s34, s41
    s_lshl_b32 s41, s42, 7
    s_add_u32 s34, s43, s41
    s_lshl_b32 s35, s42, 16
    s_add_u32 m0, s36, 73728
    s_nop 0
    buffer_load_dwordx4 v4, s[4:7], s34 offen lds
    s_add_u32 m0, s36, 74752
    s_nop 0
    buffer_load_dwordx4 v5, s[4:7], s34 offen lds
    s_add_u32 m0, s36, 75776
    s_nop 0
    buffer_load_dwordx4 v6, s[4:7], s34 offen lds
    s_add_u32 m0, s36, 76800
    s_nop 0
    buffer_load_dwordx4 v7, s[4:7], s34 offen lds
    s_add_u32 m0, s37, 73728
    s_nop 0
    buffer_load_dwordx4 v14, s[8:11], s35 offen lds
    s_add_u32 m0, s37, 74752
    s_nop 0
    buffer_load_dwordx4 v15, s[8:11], s35 offen lds
    s_add_u32 s34, s34, 128
    s_add_u32 s35, s35, 0x10000
    s_cmp_eq_u32 s35, 0x180000
    s_cselect_b32 s41, 3072, 0
    s_cselect_b32 s35, 0, s35
    s_sub_u32 s34, s34, s41
    s_lshl_b32 s41, s42, 7
    s_add_u32 s34, s43, s41
    s_add_u32 s34, s34, 2048
    s_lshl_b32 s35, s42, 16
    s_add_u32 s35, s35, 1048576
    s_add_u32 m0, s36, 98304
    s_nop 0
    buffer_load_dwordx4 v4, s[4:7], s34 offen lds
    s_add_u32 m0, s36, 99328
    s_nop 0
    buffer_load_dwordx4 v5, s[4:7], s34 offen lds
    s_add_u32 m0, s36, 100352
    s_nop 0
    buffer_load_dwordx4 v6, s[4:7], s34 offen lds
    s_add_u32 m0, s36, 101376
    s_nop 0
    buffer_load_dwordx4 v7, s[4:7], s34 offen lds
    s_add_u32 m0, s37, 98304
    s_nop 0
    buffer_load_dwordx4 v14, s[8:11], s35 offen lds
    s_add_u32 m0, s37, 99328
    s_nop 0
    buffer_load_dwordx4 v15, s[8:11], s35 offen lds
    s_add_u32 s34, s34, 128
    s_add_u32 s35, s35, 0x10000
    s_cmp_eq_u32 s35, 0x180000
    s_cselect_b32 s41, 3072, 0
    s_cselect_b32 s35, 0, s35
    s_sub_u32 s34, s34, s41
    v_add_u32 v48, 49152, v16
    v_add_u32 v49, 49152, v17
    v_add_u32 v50, 49152, v18
    v_add_u32 v51, 49152, v19
    v_add_u32 v56, 49152, v20
    v_add_u32 v57, 49152, v21
    v_add_u32 v52, 98304, v16
    v_add_u32 v53, 98304, v17
    v_add_u32 v54, 98304, v18
    v_add_u32 v55, 98304, v19
    v_add_u32 v58, 98304, v20
    v_add_u32 v59, 98304, v21
    s_waitcnt vmcnt(24)
    s_barrier
    ds_read_b128 v[24:27], v16 offset:0
    ds_read_b64_tr_b16 v[28:29], v20 offset:0
    ds_read_b64_tr_b16 v[30:31], v20 offset:512
    ds_read_b64_tr_b16 v[32:33], v21 offset:0
    ds_read_b64_tr_b16 v[34:35], v21 offset:512
    s_waitcnt lgkmcnt(0)
    ds_read_b128 v[36:39], v17 offset:0
    ds_read_b64_tr_b16 v[40:41], v20 offset:2048
    ds_read_b64_tr_b16 v[42:43], v20 offset:2560
    ds_read_b64_tr_b16 v[44:45], v21 offset:2048
    ds_read_b64_tr_b16 v[46:47], v21 offset:2560
    v_mfma_f32_32x32x16_bf16 v[64:79], v[24:27], v[28:31], v[64:79]
    v_mfma_f32_32x32x16_bf16 v[80:95], v[24:27], v[32:35], v[80:95]
    s_waitcnt lgkmcnt(0)
    ds_read_b128 v[24:27], v18 offset:0
    ds_read_b64_tr_b16 v[28:29], v20 offset:4096
    ds_read_b64_tr_b16 v[30:31], v20 offset:4608
    ds_read_b64_tr_b16 v[32:33], v21 offset:4096
    ds_read_b64_tr_b16 v[34:35], v21 offset:4608
    v_mfma_f32_32x32x16_bf16 v[64:79], v[36:39], v[40:43], v[64:79]
    v_mfma_f32_32x32x16_bf16 v[80:95], v[36:39], v[44:47], v[80:95]
    s_waitcnt vmcnt(18)
    s_barrier
    s_lshl_b32 s41, s42, 7
    s_add_u32 s34, s43, s41
    s_add_u32 s34, s34, 1024
    s_lshl_b32 s35, s42, 16
    s_add_u32 s35, s35, 524288
    s_add_u32 s42, s42, 1
    s_and_b32 s42, s42, 7
    s_add_u32 m0, s36, 122880
    s_nop 0
    buffer_load_dwordx4 v4, s[4:7], s34 offen lds
    s_add_u32 m0, s36, 123904
    s_nop 0
    buffer_load_dwordx4 v5, s[4:7], s34 offen lds
    s_add_u32 m0, s36, 124928
    s_nop 0
    buffer_load_dwordx4 v6, s[4:7], s34 offen lds
    s_add_u32 m0, s36, 125952
    s_nop 0
    buffer_load_dwordx4 v7, s[4:7], s34 offen lds
    s_add_u32 m0, s37, 122880
    s_nop 0
    buffer_load_dwordx4 v14, s[8:11], s35 offen lds
    s_add_u32 m0, s37, 123904
    s_nop 0
    buffer_load_dwordx4 v15, s[8:11], s35 offen lds
    s_add_u32 s34, s34, 128
    s_add_u32 s35, s35, 0x10000
    s_cmp_eq_u32 s35, 0x180000
    s_cselect_b32 s41, 3072, 0
    s_cselect_b32 s35, 0, s35
    s_sub_u32 s34, s34, s41
    s_waitcnt lgkmcnt(0)
    ds_read_b128 v[36:39], v19 offset:0
    ds_read_b64_tr_b16 v[40:41], v20 offset:6144
    ds_read_b64_tr_b16 v[42:43], v20 offset:6656
    ds_read_b64_tr_b16 v[44:45], v21 offset:6144
    ds_read_b64_tr_b16 v[46:47], v21 offset:6656
    v_mfma_f32_32x32x16_bf16 v[64:79], v[24:27], v[28:31], v[64:79]
    v_mfma_f32_32x32x16_bf16 v[80:95], v[24:27], v[32:35], v[80:95]
    s_waitcnt lgkmcnt(0)
    ds_read_b128 v[24:27], v16 offset:24576
    ds_read_b64_tr_b16 v[28:29], v20 offset:24576
    ds_read_b64_tr_b16 v[30:31], v20 offset:25088
    ds_read_b64_tr_b16 v[32:33], v21 offset:24576
    ds_read_b64_tr_b16 v[34:35], v21 offset:25088
    v_mfma_f32_32x32x16_bf16 v[64:79], v[36:39], v[40:43], v[64:79]
    v_mfma_f32_32x32x16_bf16 v[80:95], v[36:39], v[44:47], v[80:95]
    s_waitcnt lgkmcnt(0)
    ds_read_b128 v[36:39], v17 offset:24576
    ds_read_b64_tr_b16 v[40:41], v20 offset:26624
    ds_read_b64_tr_b16 v[42:43], v20 offset:27136
    ds_read_b64_tr_b16 v[44:45], v21 offset:26624
    ds_read_b64_tr_b16 v[46:47], v21 offset:27136
    v_mfma_f32_32x32x16_bf16 v[64:79], v[24:27], v[28:31], v[64:79]
    v_mfma_f32_32x32x16_bf16 v[80:95], v[24:27], v[32:35], v[80:95]
    s_waitcnt lgkmcnt(0)
    ds_read_b128 v[24:27], v18 offset:24576
    ds_read_b64_tr_b16 v[28:29], v20 offset:28672
    ds_read_b64_tr_b16 v[30:31], v20 offset:29184
    ds_read_b64_tr_b16 v[32:33], v21 offset:28672
    ds_read_b64_tr_b16 v[34:35], v21 offset:29184
    v_mfma_f32_32x32x16_bf16 v[64:79], v[36:39], v[40:43], v[64:79]
    v_mfma_f32_32x32x16_bf16 v[80:95], v[36:39], v[44:47], v[80:95]
    s_waitcnt vmcnt(18)
    s_barrier
    s_lshl_b32 s41, s42, 7
    s_add_u32 s34, s43, s41
    s_lshl_b32 s35, s42, 16
    s_add_u32 m0, s36, 0
    s_nop 0
    buffer_load_dwordx4 v4, s[4:7], s34 offen lds
    s_add_u32 m0, s36, 1024
    s_nop 0
    buffer_load_dwordx4 v5, s[4:7], s34 offen lds
    s_add_u32 m0, s36, 2048
    s_nop 0
    buffer_load_dwordx4 v6, s[4:7], s34 offen lds
    s_add_u32 m0, s36, 3072
    s_nop 0
    buffer_load_dwordx4 v7, s[4:7], s34 offen lds
    s_add_u32 m0, s37, 0
    s_nop 0
    buffer_load_dwordx4 v14, s[8:11], s35 offen lds
    s_add_u32 m0, s37, 1024
    s_nop 0
    buffer_load_dwordx4 v15, s[8:11], s35 offen lds
    s_add_u32 s34, s34, 128
    s_add_u32 s35, s35, 0x10000
    s_cmp_eq_u32 s35, 0x180000
    s_cselect_b32 s41, 3072, 0
    s_cselect_b32 s35, 0, s35
    s_sub_u32 s34, s34, s41
    s_waitcnt lgkmcnt(0)
    ds_read_b128 v[36:39], v19 offset:24576
    ds_read_b64_tr_b16 v[40:41], v20 offset:30720
    ds_read_b64_tr_b16 v[42:43], v20 offset:31232
    ds_read_b64_tr_b16 v[44:45], v21 offset:30720
    ds_read_b64_tr_b16 v[46:47], v21 offset:31232
    v_mfma_f32_32x32x16_bf16 v[64:79], v[24:27], v[28:31], v[64:79]
    v_mfma_f32_32x32x16_bf16 v[80:95], v[24:27], v[32:35], v[80:95]
    s_waitcnt lgkmcnt(0)
    ds_read_b128 v[24:27], v48 offset:0
    ds_read_b64_tr_b16 v[28:29], v56 offset:0
    ds_read_b64_tr_b16 v[30:31], v56 offset:512
    ds_read_b64_tr_b16 v[32:33], v57 offset:0
    ds_read_b64_tr_b16 v[34:35], v57 offset:512
    v_mfma_f32_32x32x16_bf16 v[64:79], v[36:39], v[40:43], v[64:79]
    v_mfma_f32_32x32x16_bf16 v[80:95], v[36:39], v[44:47], v[80:95]
    s_waitcnt lgkmcnt(0)
    ds_read_b128 v[36:39], v49 offset:0
    ds_read_b64_tr_b16 v[40:41], v56 offset:2048
    ds_read_b64_tr_b16 v[42:43], v56 offset:2560
    ds_read_b64_tr_b16 v[44:45], v57 offset:2048
    ds_read_b64_tr_b16 v[46:47], v57 offset:2560
    v_mfma_f32_32x32x16_bf16 v[64:79], v[24:27], v[28:31], v[64:79]
    v_mfma_f32_32x32x16_bf16 v[80:95], v[24:27], v[32:35], v[80:95]
    s_waitcnt lgkmcnt(0)
    ds_read_b128 v[24:27], v50 offset:0
    ds_read_b64_tr_b16 v[28:29], v56 offset:4096
    ds_read_b64_tr_b16 v[30:31], v56 offset:4608
    ds_read_b64_tr_b16 v[32:33], v57 offset:4096
    ds_read_b64_tr_b16 v[34:35], v57 offset:4608
    v_mfma_f32_32x32x16_bf16 v[64:79], v[36:39], v[40:43], v[64:79]
    v_mfma_f32_32x32x16_bf16 v[80:95], v[36:39], v[44:47], v[80:95]
    s_waitcnt vmcnt(18)
    s_barrier
    s_lshl_b32 s41, s42, 7
    s_add_u32 s34, s43, s41
    s_add_u32 s34, s34, 2048
    s_lshl_b32 s35, s42, 16
    s_add_u32 s35, s35, 1048576
    s_add_u32 m0, s36, 24576
    s_nop 0
    buffer_load_dwordx4 v4, s[4:7], s34 offen lds
    s_add_u32 m0, s36, 25600
    s_nop 0
    buffer_load_dwordx4 v5, s[4:7], s34 offen lds
    s_add_u32 m0, s36, 26624
    s_nop 0
    buffer_load_dwordx4 v6, s[4:7], s34 offen lds
    s_add_u32 m0, s36, 27648
    s_nop 0
    buffer_load_dwordx4 v7, s[4:7], s34 offen lds
    s_add_u32 m0, s37, 24576
    s_nop 0
    buffer_load_dwordx4 v14, s[8:11], s35 offen lds
    s_add_u32 m0, s37, 25600
    s_nop 0
    buffer_load_dwordx4 v15, s[8:11], s35 offen lds
    s_add_u32 s34, s34, 128
    s_add_u32 s35, s35, 0x10000
    s_cmp_eq_u32 s35, 0x180000
    s_cselect_b32 s41, 3072, 0
    s_cselect_b32 s35, 0, s35
    s_sub_u32 s34, s34, s41
    s_waitcnt lgkmcnt(0)
    ds_read_b128 v[36:39], v51 offset:0
    ds_read_b64_tr_b16 v[40:41], v56 offset:6144
    ds_read_b64_tr_b16 v[42:43], v56 offset:6656
    ds_read_b64_tr_b16 v[44:45], v57 offset:6144
    ds_read_b64_tr_b16 v[46:47], v57 offset:6656
    v_mfma_f32_32x32x16_bf16 v[64:79], v[24:27], v[28:31], v[64:79]
    v_mfma_f32_32x32x16_bf16 v[80:95], v[24:27], v[32:35], v[80:95]
    s_waitcnt lgkmcnt(0)
    ds_read_b128 v[24:27], v48 offset:24576
    ds_read_b64_tr_b16 v[28:29], v56 offset:24576
    ds_read_b64_tr_b16 v[30:31], v56 offset:25088
    ds_read_b64_tr_b16 v[32:33], v57 offset:24576
    ds_read_b64_tr_b16 v[34:35], v57 offset:25088
    v_mfma_f32_32x32x16_bf16 v[64:79], v[36:39], v[40:43], v[64:79]
    v_mfma_f32_32x32x16_bf16 v[80:95], v[36:39], v[44:47], v[80:95]
    s_waitcnt lgkmcnt(0)
    ds_read_b128 v[36:39], v49 offset:24576
    ds_read_b64_tr_b16 v[40:41], v56 offset:26624
    ds_read_b64_tr_b16 v[42:43], v56 offset:27136
    ds_read_b64_tr_b16 v[44:45], v57 offset:26624
    ds_read_b64_tr_b16 v[46:47], v57 offset:27136
    v_mfma_f32_32x32x16_bf16 v[64:79], v[24:27], v[28:31], v[64:79]
    v_mfma_f32_32x32x16_bf16 v[80:95], v[24:27], v[32:35], v[80:95]
    s_waitcnt lgkmcnt(0)
    ds_read_b128 v[24:27], v50 offset:24576
    ds_read_b64_tr_b16 v[28:29], v56 offset:28672
    ds_read_b64_tr_b16 v[30:31], v56 offset:29184
    ds_read_b64_tr_b16 v[32:33], v57 offset:28672
    ds_read_b64_tr_b16 v[34:35], v57 offset:29184
    v_mfma_f32_32x32x16_bf16 v[64:79], v[36:39], v[40:43], v[64:79]
    v_mfma_f32_32x32x16_bf16 v[80:95], v[36:39], v[44:47], v[80:95]
    s_waitcnt vmcnt(18)
    s_barrier
    s_lshl_b32 s41, s42, 7
    s_add_u32 s34, s43, s41
    s_add_u32 s34, s34, 1024
    s_lshl_b32 s35, s42, 16
    s_add_u32 s35, s35, 524288
    s_add_u32 s42, s42, 1
    s_and_b32 s42, s42, 7
    s_add_u32 m0, s36, 49152
    s_nop 0
    buffer_load_dwordx4 v4, s[4:7], s34 offen lds
    s_add_u32 m0, s36, 50176
    s_nop 0
    buffer_load_dwordx4 v5, s[4:7], s34 offen lds
    s_add_u32 m0, s36, 51200
    s_nop 0
    buffer_load_dwordx4 v6, s[4:7], s34 offen lds
    s_add_u32 m0, s36, 52224
    s_nop 0
    buffer_load_dwordx4 v7, s[4:7], s34 offen lds
    s_add_u32 m0, s37, 49152
    s_nop 0
    buffer_load_dwordx4 v14, s[8:11], s35 offen lds
    s_add_u32 m0, s37, 50176
    s_nop 0
    buffer_load_dwordx4 v15, s[8:11], s35 offen lds
    s_add_u32 s34, s34, 128
    s_add_u32 s35, s35, 0x10000
    s_cmp_eq_u32 s35, 0x180000
    s_cselect_b32 s41, 3072, 0
    s_cselect_b32 s35, 0, s35
    s_sub_u32 s34, s34, s41
    s_waitcnt lgkmcnt(0)
    ds_read_b128 v[36:39], v51 offset:24576
    ds_read_b64_tr_b16 v[40:41], v56 offset:30720
    ds_read_b64_tr_b16 v[42:43], v56 offset:31232
    ds_read_b64_tr_b16 v[44:45], v57 offset:30720
    ds_read_b64_tr_b16 v[46:47], v57 offset:31232
    v_mfma_f32_32x32x16_bf16 v[64:79], v[24:27], v[28:31], v[64:79]
    v_mfma_f32_32x32x16_bf16 v[80:95], v[24:27], v[32:35], v[80:95]
    s_waitcnt lgkmcnt(0)
    ds_read_b128 v[24:27], v52 offset:0
    ds_read_b64_tr_b16 v[28:29], v58 offset:0
    ds_read_b64_tr_b16 v[30:31], v58 offset:512
    ds_read_b64_tr_b16 v[32:33], v59 offset:0
    ds_read_b64_tr_b16 v[34:35], v59 offset:512
    v_mfma_f32_32x32x16_bf16 v[64:79], v[36:39], v[40:43], v[64:79]
    v_mfma_f32_32x32x16_bf16 v[80:95], v[36:39], v[44:47], v[80:95]
    s_waitcnt lgkmcnt(0)
    ds_read_b128 v[36:39], v53 offset:0
    ds_read_b64_tr_b16 v[40:41], v58 offset:2048
    ds_read_b64_tr_b16 v[42:43], v58 offset:2560
    ds_read_b64_tr_b16 v[44:45], v59 offset:2048
    ds_read_b64_tr_b16 v[46:47], v59 offset:2560
    v_mfma_f32_32x32x16_bf16 v[64:79], v[24:27], v[28:31], v[64:79]
    v_mfma_f32_32x32x16_bf16 v[80:95], v[24:27], v[32:35], v[80:95]
    s_waitcnt lgkmcnt(0)
    ds_read_b128 v[24:27], v54 offset:0
    ds_read_b64_tr_b16 v[28:29], v58 offset:4096
    ds_read_b64_tr_b16 v[30:31], v58 offset:4608
    ds_read_b64_tr_b16 v[32:33], v59 offset:4096
    ds_read_b64_tr_b16 v[34:35], v59 offset:4608
    v_mfma_f32_32x32x16_bf16 v[64:79], v[36:39], v[40:43], v[64:79]
    v_mfma_f32_32x32x16_bf16 v[80:95], v[36:39], v[44:47], v[80:95]
    s_waitcnt vmcnt(18)
    s_barrier
    s_lshl_b32 s41, s42, 7
    s_add_u32 s34, s43, s41
    s_lshl_b32 s35, s42, 16
    s_add_u32 m0, s36, 73728
    s_nop 0
    buffer_load_dwordx4 v4, s[4:7], s34 offen lds
    s_add_u32 m0, s36, 74752
    s_nop 0
    buffer_load_dwordx4 v5, s[4:7], s34 offen lds
    s_add_u32 m0, s36, 75776
    s_nop 0
    buffer_load_dwordx4 v6, s[4:7], s34 offen lds
    s_add_u32 m0, s36, 76800
    s_nop 0
    buffer_load_dwordx4 v7, s[4:7], s34 offen lds
    s_add_u32 m0, s37, 73728
    s_nop 0
    buffer_load_dwordx4 v14, s[8:11], s35 offen lds
    s_add_u32 m0, s37, 74752
    s_nop 0
    buffer_load_dwordx4 v15, s[8:11], s35 offen lds
    s_add_u32 s34, s34, 128
    s_add_u32 s35, s35, 0x10000
    s_cmp_eq_u32 s35, 0x180000
    s_cselect_b32 s41, 3072, 0
    s_cselect_b32 s35, 0, s35
    s_sub_u32 s34, s34, s41
    s_waitcnt lgkmcnt(0)
    ds_read_b128 v[36:39], v55 offset:0
    ds_read_b64_tr_b16 v[40:41], v58 offset:6144
    ds_read_b64_tr_b16 v[42:43], v58 offset:6656
    ds_read_b64_tr_b16 v[44:45], v59 offset:6144
    ds_read_b64_tr_b16 v[46:47], v59 offset:6656
    v_mfma_f32_32x32x16_bf16 v[64:79], v[24:27], v[28:31], v[64:79]
    v_mfma_f32_32x32x16_bf16 v[80:95], v[24:27], v[32:35], v[80:95]
    s_waitcnt lgkmcnt(0)
    ds_read_b128 v[24:27], v52 offset:24576
    ds_read_b64_tr_b16 v[28:29], v58 offset:24576
    ds_read_b64_tr_b16 v[30:31], v58 offset:25088
    ds_read_b64_tr_b16 v[32:33], v59 offset:24576
    ds_read_b64_tr_b16 v[34:35], v59 offset:25088
    v_mfma_f32_32x32x16_bf16 v[64:79], v[36:39], v[40:43], v[64:79]
    v_mfma_f32_32x32x16_bf16 v[80:95], v[36:39], v[44:47], v[80:95]
    s_waitcnt lgkmcnt(0)
    ds_read_b128 v[36:39], v53 offset:24576
    ds_read_b64_tr_b16 v[40:41], v58 offset:26624
    ds_read_b64_tr_b16 v[42:43], v58 offset:27136
    ds_read_b64_tr_b16 v[44:45], v59 offset:26624
    ds_read_b64_tr_b16 v[46:47], v59 offset:27136
    v_mfma_f32_32x32x16_bf16 v[64:79], v[24:27], v[28:31], v[64:79]
    v_mfma_f32_32x32x16_bf16 v[80:95], v[24:27], v[32:35], v[80:95]
    s_waitcnt lgkmcnt(0)
    ds_read_b128 v[24:27], v54 offset:24576
    ds_read_b64_tr_b16 v[28:29], v58 offset:28672
    ds_read_b64_tr_b16 v[30:31], v58 offset:29184
    ds_read_b64_tr_b16 v[32:33], v59 offset:28672
    ds_read_b64_tr_b16 v[34:35], v59 offset:29184
    v_mfma_f32_32x32x16_bf16 v[64:79], v[36:39], v[40:43], v[64:79]
    v_mfma_f32_32x32x16_bf16 v[80:95], v[36:39], v[44:47], v[80:95]
    s_waitcnt vmcnt(18)
    s_barrier
    s_lshl_b32 s41, s42, 7
    s_add_u32 s34, s43, s41
    s_add_u32 s34, s34, 2048
    s_lshl_b32 s35, s42, 16
    s_add_u32 s35, s35, 1048576
    s_add_u32 m0, s36, 98304
    s_nop 0
    buffer_load_dwordx4 v4, s[4:7], s34 offen lds
    s_add_u32 m0, s36, 99328
    s_nop 0
    buffer_load_dwordx4 v5, s[4:7], s34 offen lds
    s_add_u32 m0, s36, 100352
    s_nop 0
    buffer_load_dwordx4 v6, s[4:7], s34 offen lds
    s_add_u32 m0, s36, 101376
    s_nop 0
    buffer_load_dwordx4 v7, s[4:7], s34 offen lds
    s_add_u32 m0, s37, 98304
    s_nop 0
    buffer_load_dwordx4 v14, s[8:11], s35 offen lds
    s_add_u32 m0, s37, 99328
    s_nop 0
    buffer_load_dwordx4 v15, s[8:11], s35 offen lds
    s_add_u32 s34, s34, 128
    s_add_u32 s35, s35, 0x10000
    s_cmp_eq_u32 s35, 0x180000
    s_cselect_b32 s41, 3072, 0
    s_cselect_b32 s35, 0, s35
    s_sub_u32 s34, s34, s41
    s_waitcnt lgkmcnt(0)
    ds_read_b128 v[36:39], v55 offset:24576
    ds_read_b64_tr_b16 v[40:41], v58 offset:30720
    ds_read_b64_tr_b16 v[42:43], v58 offset:31232
    ds_read_b64_tr_b16 v[44:45], v59 offset:30720
    ds_read_b64_tr_b16 v[46:47], v59 offset:31232
    v_mfma_f32_32x32x16_bf16 v[64:79], v[24:27], v[28:31], v[64:79]
    v_mfma_f32_32x32x16_bf16 v[80:95], v[24:27], v[32:35], v[80:95]
    s_waitcnt lgkmcnt(0)
    ds_read_b128 v[24:27], v16 offset:0
    ds_read_b64_tr_b16 v[28:29], v20 offset:0
    ds_read_b64_tr_b16 v[30:31], v20 offset:512
    ds_read_b64_tr_b16 v[32:33], v21 offset:0
    ds_read_b64_tr_b16 v[34:35], v21 offset:512
    v_mfma_f32_32x32x16_bf16 v[64:79], v[36:39], v[40:43], v[64:79]
    v_mfma_f32_32x32x16_bf16 v[80:95], v[36:39], v[44:47], v[80:95]
    s_waitcnt lgkmcnt(0)
    ds_read_b128 v[36:39], v17 offset:0
    ds_read_b64_tr_b16 v[40:41], v20 offset:2048
    ds_read_b64_tr_b16 v[42:43], v20 offset:2560
    ds_read_b64_tr_b16 v[44:45], v21 offset:2048
    ds_read_b64_tr_b16 v[46:47], v21 offset:2560
    v_mfma_f32_32x32x16_bf16 v[64:79], v[24:27], v[28:31], v[64:79]
    v_mfma_f32_32x32x16_bf16 v[80:95], v[24:27], v[32:35], v[80:95]
    s_waitcnt lgkmcnt(0)
    ds_read_b128 v[24:27], v18 offset:0
    ds_read_b64_tr_b16 v[28:29], v20 offset:4096
    ds_read_b64_tr_b16 v[30:31], v20 offset:4608
    ds_read_b64_tr_b16 v[32:33], v21 offset:4096
    ds_read_b64_tr_b16 v[34:35], v21 offset:4608
    v_mfma_f32_32x32x16_bf16 v[64:79], v[36:39], v[40:43], v[64:79]
    v_mfma_f32_32x32x16_bf16 v[80:95], v[36:39], v[44:47], v[80:95]
    s_waitcnt vmcnt(18)
    s_barrier
    s_lshl_b32 s41, s42, 7
    s_add_u32 s34, s43, s41
    s_add_u32 s34, s34, 1024
    s_lshl_b32 s35, s42, 16
    s_add_u32 s35, s35, 524288
    s_add_u32 s42, s42, 1
    s_and_b32 s42, s42, 7
    s_add_u32 m0, s36, 122880
    s_nop 0
    buffer_load_dwordx4 v4, s[4:7], s34 offen lds
    s_add_u32 m0, s36, 123904
    s_nop 0
    buffer_load_dwordx4 v5, s[4:7], s34 offen lds
    s_add_u32 m0, s36, 124928
    s_nop 0
    buffer_load_dwordx4 v6, s[4:7], s34 offen lds
    s_add_u32 m0, s36, 125952
    s_nop 0
    buffer_load_dwordx4 v7, s[4:7], s34 offen lds
    s_add_u32 m0, s37, 122880
    s_nop 0
    buffer_load_dwordx4 v14, s[8:11], s35 offen lds
    s_add_u32 m0, s37, 123904
    s_nop 0
    buffer_load_dwordx4 v15, s[8:11], s35 offen lds
    s_add_u32 s34, s34, 128
    s_add_u32 s35, s35, 0x10000
    s_cmp_eq_u32 s35, 0x180000
    s_cselect_b32 s41, 3072, 0
    s_cselect_b32 s35, 0, s35
    s_sub_u32 s34, s34, s41
    s_waitcnt lgkmcnt(0)
    ds_read_b128 v[36:39], v19 offset:0
    ds_read_b64_tr_b16 v[40:41], v20 offset:6144
    ds_read_b64_tr_b16 v[42:43], v20 offset:6656
    ds_read_b64_tr_b16 v[44:45], v21 offset:6144
    ds_read_b64_tr_b16 v[46:47], v21 offset:6656
    v_mfma_f32_32x32x16_bf16 v[64:79], v[24:27], v[28:31], v[64:79]
    v_mfma_f32_32x32x16_bf16 v[80:95], v[24:27], v[32:35], v[80:95]
    s_waitcnt lgkmcnt(0)
    ds_read_b128 v[24:27], v16 offset:24576
    ds_read_b64_tr_b16 v[28:29], v20 offset:24576
    ds_read_b64_tr_b16 v[30:31], v20 offset:25088
    ds_read_b64_tr_b16 v[32:33], v21 offset:24576
    ds_read_b64_tr_b16 v[34:35], v21 offset:25088
    v_mfma_f32_32x32x16_bf16 v[64:79], v[36:39], v[40:43], v[64:79]
    v_mfma_f32_32x32x16_bf16 v[80:95], v[36:39], v[44:47], v[80:95]
    s_waitcnt lgkmcnt(0)
    ds_read_b128 v[36:39], v17 offset:24576
    ds_read_b64_tr_b16 v[40:41], v20 offset:26624
    ds_read_b64_tr_b16 v[42:43], v20 offset:27136
    ds_read_b64_tr_b16 v[44:45], v21 offset:26624
    ds_read_b64_tr_b16 v[46:47], v21 offset:27136
    v_mfma_f32_32x32x16_bf16 v[64:79], v[24:27], v[28:31], v[64:79]
    v_mfma_f32_32x32x16_bf16 v[80:95], v[24:27], v[32:35], v[80:95]
    s_waitcnt lgkmcnt(0)
    ds_read_b128 v[24:27], v18 offset:24576
    ds_read_b64_tr_b16 v[28:29], v20 offset:28672
    ds_read_b64_tr_b16 v[30:31], v20 offset:29184
    ds_read_b64_tr_b16 v[32:33], v21 offset:28672
    ds_read_b64_tr_b16 v[34:35], v21 offset:29184
    v_mfma_f32_32x32x16_bf16 v[64:79], v[36:39], v[40:43], v[64:79]
    v_mfma_f32_32x32x16_bf16 v[80:95], v[36:39], v[44:47], v[80:95]
    s_waitcnt vmcnt(18)
    s_barrier
    s_lshl_b32 s41, s42, 7
    s_add_u32 s34, s43, s41
    s_lshl_b32 s35, s42, 16
    s_add_u32 m0, s36, 0
    s_nop 0
    buffer_load_dwordx4 v4, s[4:7], s34 offen lds
    s_add_u32 m0, s36, 1024
    s_nop 0
    buffer_load_dwordx4 v5, s[4:7], s34 offen lds
    s_add_u32 m0, s36, 2048
    s_nop 0
    buffer_load_dwordx4 v6, s[4:7], s34 offen lds
    s_add_u32 m0, s36, 3072
    s_nop 0
    buffer_load_dwordx4 v7, s[4:7], s34 offen lds
    s_add_u32 m0, s37, 0
    s_nop 0
    buffer_load_dwordx4 v14, s[8:11], s35 offen lds
    s_add_u32 m0, s37, 1024
    s_nop 0
    buffer_load_dwordx4 v15, s[8:11], s35 offen lds
    s_add_u32 s34, s34, 128
    s_add_u32 s35, s35, 0x10000
    s_cmp_eq_u32 s35, 0x180000
    s_cselect_b32 s41, 3072, 0
    s_cselect_b32 s35, 0, s35
    s_sub_u32 s34, s34, s41
    s_waitcnt lgkmcnt(0)
    ds_read_b128 v[36:39], v19 offset:24576
    ds_read_b64_tr_b16 v[40:41], v20 offset:30720
    ds_read_b64_tr_b16 v[42:43], v20 offset:31232
    ds_read_b64_tr_b16 v[44:45], v21 offset:30720
    ds_read_b64_tr_b16 v[46:47], v21 offset:31232
    v_mfma_f32_32x32x16_bf16 v[64:79], v[24:27], v[28:31], v[64:79]
    v_mfma_f32_32x32x16_bf16 v[80:95], v[24:27], v[32:35], v[80:95]
    s_waitcnt lgkmcnt(0)
    ds_read_b128 v[24:27], v48 offset:0
    ds_read_b64_tr_b16 v[28:29], v56 offset:0
    ds_read_b64_tr_b16 v[30:31], v56 offset:512
    ds_read_b64_tr_b16 v[32:33], v57 offset:0
    ds_read_b64_tr_b16 v[34:35], v57 offset:512
    v_mfma_f32_32x32x16_bf16 v[64:79], v[36:39], v[40:43], v[64:79]
    v_mfma_f32_32x32x16_bf16 v[80:95], v[36:39], v[44:47], v[80:95]
    s_waitcnt lgkmcnt(0)
    ds_read_b128 v[36:39], v49 offset:0
    ds_read_b64_tr_b16 v[40:41], v56 offset:2048
    ds_read_b64_tr_b16 v[42:43], v56 offset:2560
    ds_read_b64_tr_b16 v[44:45], v57 offset:2048
    ds_read_b64_tr_b16 v[46:47], v57 offset:2560
    v_mfma_f32_32x32x16_bf16 v[64:79], v[24:27], v[28:31], v[64:79]
    v_mfma_f32_32x32x16_bf16 v[80:95], v[24:27], v[32:35], v[80:95]
    s_waitcnt lgkmcnt(0)
    ds_read_b128 v[24:27], v50 offset:0
    ds_read_b64_tr_b16 v[28:29], v56 offset:4096
    ds_read_b64_tr_b16 v[30:31], v56 offset:4608
    ds_read_b64_tr_b16 v[32:33], v57 offset:4096
    ds_read_b64_tr_b16 v[34:35], v57 offset:4608
    v_mfma_f32_32x32x16_bf16 v[64:79], v[36:39], v[40:43], v[64:79]
    v_mfma_f32_32x32x16_bf16 v[80:95], v[36:39], v[44:47], v[80:95]
    s_waitcnt vmcnt(18)
    s_barrier
    s_lshl_b32 s41, s42, 7
    s_add_u32 s34, s43, s41
    s_add_u32 s34, s34, 2048
    s_lshl_b32 s35, s42, 16
    s_add_u32 s35, s35, 1048576
    s_add_u32 m0, s36, 24576
    s_nop 0
    buffer_load_dwordx4 v4, s[4:7], s34 offen lds
    s_add_u32 m0, s36, 25600
    s_nop 0
    buffer_load_dwordx4 v5, s[4:7], s34 offen lds
    s_add_u32 m0, s36, 26624
    s_nop 0
    buffer_load_dwordx4 v6, s[4:7], s34 offen lds
    s_add_u32 m0, s36, 27648
    s_nop 0
    buffer_load_dwordx4 v7, s[4:7], s34 offen lds
    s_add_u32 m0, s37, 24576
    s_nop 0
    buffer_load_dwordx4 v14, s[8:11], s35 offen lds
    s_add_u32 m0, s37, 25600
    s_nop 0
    buffer_load_dwordx4 v15, s[8:11], s35 offen lds
    s_add_u32 s34, s34, 128
    s_add_u32 s35, s35, 0x10000
    s_cmp_eq_u32 s35, 0x180000
    s_cselect_b32 s41, 3072, 0
    s_cselect_b32 s35, 0, s35
    s_sub_u32 s34, s34, s41
    s_waitcnt lgkmcnt(0)
    ds_read_b128 v[36:39], v51 offset:0
    ds_read_b64_tr_b16 v[40:41], v56 offset:6144
    ds_read_b64_tr_b16 v[42:43], v56 offset:6656
    ds_read_b64_tr_b16 v[44:45], v57 offset:6144
    ds_read_b64_tr_b16 v[46:47], v57 offset:6656
    v_mfma_f32_32x32x16_bf16 v[64:79], v[24:27], v[28:31], v[64:79]
    v_mfma_f32_32x32x16_bf16 v[80:95], v[24:27], v[32:35], v[80:95]
    s_waitcnt lgkmcnt(0)
    ds_read_b128 v[24:27], v48 offset:24576
    ds_read_b64_tr_b16 v[28:29], v56 offset:24576
    ds_read_b64_tr_b16 v[30:31], v56 offset:25088
    ds_read_b64_tr_b16 v[32:33], v57 offset:24576
    ds_read_b64_tr_b16 v[34:35], v57 offset:25088
    v_mfma_f32_32x32x16_bf16 v[64:79], v[36:39], v[40:43], v[64:79]
    v_mfma_f32_32x32x16_bf16 v[80:95], v[36:39], v[44:47], v[80:95]
    s_waitcnt lgkmcnt(0)
    ds_read_b128 v[36:39], v49 offset:24576
    ds_read_b64_tr_b16 v[40:41], v56 offset:26624
    ds_read_b64_tr_b16 v[42:43], v56 offset:27136
    ds_read_b64_tr_b16 v[44:45], v57 offset:26624
    ds_read_b64_tr_b16 v[46:47], v57 offset:27136
    v_mfma_f32_32x32x16_bf16 v[64:79], v[24:27], v[28:31], v[64:79]
    v_mfma_f32_32x32x16_bf16 v[80:95], v[24:27], v[32:35], v[80:95]
    s_waitcnt lgkmcnt(0)
    ds_read_b128 v[24:27], v50 offset:24576
    ds_read_b64_tr_b16 v[28:29], v56 offset:28672
    ds_read_b64_tr_b16 v[30:31], v56 offset:29184
    ds_read_b64_tr_b16 v[32:33], v57 offset:28672
    ds_read_b64_tr_b16 v[34:35], v57 offset:29184
    v_mfma_f32_32x32x16_bf16 v[64:79], v[36:39], v[40:43], v[64:79]
    v_mfma_f32_32x32x16_bf16 v[80:95], v[36:39], v[44:47], v[80:95]
    s_waitcnt vmcnt(18)
    s_barrier
    s_lshl_b32 s41, s42, 7
    s_add_u32 s34, s43, s41
    s_add_u32 s34, s34, 1024
    s_lshl_b32 s35, s42, 16
    s_add_u32 s35, s35, 524288
    s_add_u32 s42, s42, 1
    s_and_b32 s42, s42, 7
    s_add_u32 m0, s36, 49152
    s_nop 0
    buffer_load_dwordx4 v4, s[4:7], s34 offen lds
    s_add_u32 m0, s36, 50176
    s_nop 0
    buffer_load_dwordx4 v5, s[4:7], s34 offen lds
    s_add_u32 m0, s36, 51200
    s_nop 0
    buffer_load_dwordx4 v6, s[4:7], s34 offen lds
    s_add_u32 m0, s36, 52224
    s_nop 0
    buffer_load_dwordx4 v7, s[4:7], s34 offen lds
    s_add_u32 m0, s37, 49152
    s_nop 0
    buffer_load_dwordx4 v14, s[8:11], s35 offen lds
    s_add_u32 m0, s37, 50176
    s_nop 0
    buffer_load_dwordx4 v15, s[8:11], s35 offen lds
    s_add_u32 s34, s34, 128
    s_add_u32 s35, s35, 0x10000
    s_cmp_eq_u32 s35, 0x180000
    s_cselect_b32 s41, 3072, 0
    s_cselect_b32 s35, 0, s35
    s_sub_u32 s34, s34, s41
    s_waitcnt lgkmcnt(0)
    ds_read_b128 v[36:39], v51 offset:24576
    ds_read_b64_tr_b16 v[40:41], v56 offset:30720
    ds_read_b64_tr_b16 v[42:43], v56 offset:31232
    ds_read_b64_tr_b16 v[44:45], v57 offset:30720
    ds_read_b64_tr_b16 v[46:47], v57 offset:31232
    v_mfma_f32_32x32x16_bf16 v[64:79], v[24:27], v[28:31], v[64:79]
    v_mfma_f32_32x32x16_bf16 v[80:95], v[24:27], v[32:35], v[80:95]
    s_waitcnt lgkmcnt(0)
    ds_read_b128 v[24:27], v52 offset:0
    ds_read_b64_tr_b16 v[28:29], v58 offset:0
    ds_read_b64_tr_b16 v[30:31], v58 offset:512
    ds_read_b64_tr_b16 v[32:33], v59 offset:0
    ds_read_b64_tr_b16 v[34:35], v59 offset:512
    v_mfma_f32_32x32x16_bf16 v[64:79], v[36:39], v[40:43], v[64:79]
    v_mfma_f32_32x32x16_bf16 v[80:95], v[36:39], v[44:47], v[80:95]
    s_waitcnt lgkmcnt(0)
    ds_read_b128 v[36:39], v53 offset:0
    ds_read_b64_tr_b16 v[40:41], v58 offset:2048
    ds_read_b64_tr_b16 v[42:43], v58 offset:2560
    ds_read_b64_tr_b16 v[44:45], v59 offset:2048
    ds_read_b64_tr_b16 v[46:47], v59 offset:2560
    v_mfma_f32_32x32x16_bf16 v[64:79], v[24:27], v[28:31], v[64:79]
    v_mfma_f32_32x32x16_bf16 v[80:95], v[24:27], v[32:35], v[80:95]
    s_waitcnt lgkmcnt(0)
    ds_read_b128 v[24:27], v54 offset:0
    ds_read_b64_tr_b16 v[28:29], v58 offset:4096
    ds_read_b64_tr_b16 v[30:31], v58 offset:4608
    ds_read_b64_tr_b16 v[32:33], v59 offset:4096
    ds_read_b64_tr_b16 v[34:35], v59 offset:4608
    v_mfma_f32_32x32x16_bf16 v[64:79], v[36:39], v[40:43], v[64:79]
    v_mfma_f32_32x32x16_bf16 v[80:95], v[36:39], v[44:47], v[80:95]
    s_waitcnt vmcnt(18)
    s_barrier
    s_lshl_b32 s41, s42, 7
    s_add_u32 s34, s43, s41
    s_lshl_b32 s35, s42, 16
    s_add_u32 m0, s36, 73728
    s_nop 0
    buffer_load_dwordx4 v4, s[4:7], s34 offen lds
    s_add_u32 m0, s36, 74752
    s_nop 0
    buffer_load_dwordx4 v5, s[4:7], s34 offen lds
    s_add_u32 m0, s36, 75776
    s_nop 0
    buffer_load_dwordx4 v6, s[4:7], s34 offen lds
    s_add_u32 m0, s36, 76800
    s_nop 0
    buffer_load_dwordx4 v7, s[4:7], s34 offen lds
    s_add_u32 m0, s37, 73728
    s_nop 0
    buffer_load_dwordx4 v14, s[8:11], s35 offen lds
    s_add_u32 m0, s37, 74752
    s_nop 0
    buffer_load_dwordx4 v15, s[8:11], s35 offen lds
    s_add_u32 s34, s34, 128
    s_add_u32 s35, s35, 0x10000
    s_cmp_eq_u32 s35, 0x180000
    s_cselect_b32 s41, 3072, 0
    s_cselect_b32 s35, 0, s35
    s_sub_u32 s34, s34, s41
    s_waitcnt lgkmcnt(0)
    ds_read_b128 v[36:39], v55 offset:0
    ds_read_b64_tr_b16 v[40:41], v58 offset:6144
    ds_read_b64_tr_b16 v[42:43], v58 offset:6656
    ds_read_b64_tr_b16 v[44:45], v59 offset:6144
    ds_read_b64_tr_b16 v[46:47], v59 offset:6656
    v_mfma_f32_32x32x16_bf16 v[64:79], v[24:27], v[28:31], v[64:79]
    v_mfma_f32_32x32x16_bf16 v[80:95], v[24:27], v[32:35], v[80:95]
    s_waitcnt lgkmcnt(0)
    ds_read_b128 v[24:27], v52 offset:24576
    ds_read_b64_tr_b16 v[28:29], v58 offset:24576
    ds_read_b64_tr_b16 v[30:31], v58 offset:25088
    ds_read_b64_tr_b16 v[32:33], v59 offset:24576
    ds_read_b64_tr_b16 v[34:35], v59 offset:25088
    v_mfma_f32_32x32x16_bf16 v[64:79], v[36:39], v[40:43], v[64:79]
    v_mfma_f32_32x32x16_bf16 v[80:95], v[36:39], v[44:47], v[80:95]
    s_waitcnt lgkmcnt(0)
    ds_read_b128 v[36:39], v53 offset:24576
    ds_read_b64_tr_b16 v[40:41], v58 offset:26624
    ds_read_b64_tr_b16 v[42:43], v58 offset:27136
    ds_read_b64_tr_b16 v[44:45], v59 offset:26624
    ds_read_b64_tr_b16 v[46:47], v59 offset:27136
    v_mfma_f32_32x32x16_bf16 v[64:79], v[24:27], v[28:31], v[64:79]
    v_mfma_f32_32x32x16_bf16 v[80:95], v[24:27], v[32:35], v[80:95]
    s_waitcnt lgkmcnt(0)
    ds_read_b128 v[24:27], v54 offset:24576
    ds_read_b64_tr_b16 v[28:29], v58 offset:28672
    ds_read_b64_tr_b16 v[30:31], v58 offset:29184
    ds_read_b64_tr_b16 v[32:33], v59 offset:28672
    ds_read_b64_tr_b16 v[34:35], v59 offset:29184
    v_mfma_f32_32x32x16_bf16 v[64:79], v[36:39], v[40:43], v[64:79]
    v_mfma_f32_32x32x16_bf16 v[80:95], v[36:39], v[44:47], v[80:95]
    s_waitcnt vmcnt(18)
    s_barrier
    s_lshl_b32 s41, s42, 7
    s_add_u32 s34, s43, s41
    s_add_u32 s34, s34, 2048
    s_lshl_b32 s35, s42, 16
    s_add_u32 s35, s35, 1048576
    s_add_u32 m0, s36, 98304
    s_nop 0
    buffer_load_dwordx4 v4, s[4:7], s34 offen lds
    s_add_u32 m0, s36, 99328
    s_nop 0
    buffer_load_dwordx4 v5, s[4:7], s34 offen lds
    s_add_u32 m0, s36, 100352
    s_nop 0
    buffer_load_dwordx4 v6, s[4:7], s34 offen lds
    s_add_u32 m0, s36, 101376
    s_nop 0
    buffer_load_dwordx4 v7, s[4:7], s34 offen lds
    s_add_u32 m0, s37, 98304
    s_nop 0
    buffer_load_dwordx4 v14, s[8:11], s35 offen lds
    s_add_u32 m0, s37, 99328
    s_nop 0
    buffer_load_dwordx4 v15, s[8:11], s35 offen lds
    s_add_u32 s34, s34, 128
    s_add_u32 s35, s35, 0x10000
    s_cmp_eq_u32 s35, 0x180000
    s_cselect_b32 s41, 3072, 0
    s_cselect_b32 s35, 0, s35
    s_sub_u32 s34, s34, s41
    s_waitcnt lgkmcnt(0)
    ds_read_b128 v[36:39], v55 offset:24576
    ds_read_b64_tr_b16 v[40:41], v58 offset:30720
    ds_read_b64_tr_b16 v[42:43], v58 offset:31232
    ds_read_b64_tr_b16 v[44:45], v59 offset:30720
    ds_read_b64_tr_b16 v[46:47], v59 offset:31232
    v_mfma_f32_32x32x16_bf16 v[64:79], v[24:27], v[28:31], v[64:79]
    v_mfma_f32_32x32x16_bf16 v[80:95], v[24:27], v[32:35], v[80:95]
    s_waitcnt lgkmcnt(0)
    ds_read_b128 v[24:27], v16 offset:0
    ds_read_b64_tr_b16 v[28:29], v20 offset:0
    ds_read_b64_tr_b16 v[30:31], v20 offset:512
    ds_read_b64_tr_b16 v[32:33], v21 offset:0
    ds_read_b64_tr_b16 v[34:35], v21 offset:512
    v_mfma_f32_32x32x16_bf16 v[64:79], v[36:39], v[40:43], v[64:79]
    v_mfma_f32_32x32x16_bf16 v[80:95], v[36:39], v[44:47], v[80:95]
    s_waitcnt lgkmcnt(0)
    ds_read_b128 v[36:39], v17 offset:0
    ds_read_b64_tr_b16 v[40:41], v20 offset:2048
    ds_read_b64_tr_b16 v[42:43], v20 offset:2560
    ds_read_b64_tr_b16 v[44:45], v21 offset:2048
    ds_read_b64_tr_b16 v[46:47], v21 offset:2560
    v_mfma_f32_32x32x16_bf16 v[64:79], v[24:27], v[28:31], v[64:79]
    v_mfma_f32_32x32x16_bf16 v[80:95], v[24:27], v[32:35], v[80:95]
    s_waitcnt lgkmcnt(0)
    ds_read_b128 v[24:27], v18 offset:0
    ds_read_b64_tr_b16 v[28:29], v20 offset:4096
    ds_read_b64_tr_b16 v[30:31], v20 offset:4608
    ds_read_b64_tr_b16 v[32:33], v21 offset:4096
    ds_read_b64_tr_b16 v[34:35], v21 offset:4608
    v_mfma_f32_32x32x16_bf16 v[64:79], v[36:39], v[40:43], v[64:79]
    v_mfma_f32_32x32x16_bf16 v[80:95], v[36:39], v[44:47], v[80:95]
    s_waitcnt vmcnt(18)
    s_barrier
    s_lshl_b32 s41, s42, 7
    s_add_u32 s34, s43, s41
    s_add_u32 s34, s34, 1024
    s_lshl_b32 s35, s42, 16
    s_add_u32 s35, s35, 524288
    s_add_u32 s42, s42, 1
    s_and_b32 s42, s42, 7
    s_add_u32 m0, s36, 122880
    s_nop 0
    buffer_load_dwordx4 v4, s[4:7], s34 offen lds
    s_add_u32 m0, s36, 123904
    s_nop 0
    buffer_load_dwordx4 v5, s[4:7], s34 offen lds
    s_add_u32 m0, s36, 124928
    s_nop 0
    buffer_load_dwordx4 v6, s[4:7], s34 offen lds
    s_add_u32 m0, s36, 125952
    s_nop 0
    buffer_load_dwordx4 v7, s[4:7], s34 offen lds
    s_add_u32 m0, s37, 122880
    s_nop 0
    buffer_load_dwordx4 v14, s[8:11], s35 offen lds
    s_add_u32 m0, s37, 123904
    s_nop 0
    buffer_load_dwordx4 v15, s[8:11], s35 offen lds
    s_add_u32 s34, s34, 128
    s_add_u32 s35, s35, 0x10000
    s_cmp_eq_u32 s35, 0x180000
    s_cselect_b32 s41, 3072, 0
    s_cselect_b32 s35, 0, s35
    s_sub_u32 s34, s34, s41
    s_waitcnt lgkmcnt(0)
    ds_read_b128 v[36:39], v19 offset:0
    ds_read_b64_tr_b16 v[40:41], v20 offset:6144
    ds_read_b64_tr_b16 v[42:43], v20 offset:6656
    ds_read_b64_tr_b16 v[44:45], v21 offset:6144
    ds_read_b64_tr_b16 v[46:47], v21 offset:6656
    v_mfma_f32_32x32x16_bf16 v[64:79], v[24:27], v[28:31], v[64:79]
    v_mfma_f32_32x32x16_bf16 v[80:95], v[24:27], v[32:35], v[80:95]
    s_waitcnt lgkmcnt(0)
    ds_read_b128 v[24:27], v16 offset:24576
    ds_read_b64_tr_b16 v[28:29], v20 offset:24576
    ds_read_b64_tr_b16 v[30:31], v20 offset:25088
    ds_read_b64_tr_b16 v[32:33], v21 offset:24576
    ds_read_b64_tr_b16 v[34:35], v21 offset:25088
    v_mfma_f32_32x32x16_bf16 v[64:79], v[36:39], v[40:43], v[64:79]
    v_mfma_f32_32x32x16_bf16 v[80:95], v[36:39], v[44:47], v[80:95]
    s_waitcnt lgkmcnt(0)
    ds_read_b128 v[36:39], v17 offset:24576
    ds_read_b64_tr_b16 v[40:41], v20 offset:26624
    ds_read_b64_tr_b16 v[42:43], v20 offset:27136
    ds_read_b64_tr_b16 v[44:45], v21 offset:26624
    ds_read_b64_tr_b16 v[46:47], v21 offset:27136
    v_mfma_f32_32x32x16_bf16 v[64:79], v[24:27], v[28:31], v[64:79]
    v_mfma_f32_32x32x16_bf16 v[80:95], v[24:27], v[32:35], v[80:95]
    s_waitcnt lgkmcnt(0)
    ds_read_b128 v[24:27], v18 offset:24576
    ds_read_b64_tr_b16 v[28:29], v20 offset:28672
    ds_read_b64_tr_b16 v[30:31], v20 offset:29184
    ds_read_b64_tr_b16 v[32:33], v21 offset:28672
    ds_read_b64_tr_b16 v[34:35], v21 offset:29184
    v_mfma_f32_32x32x16_bf16 v[64:79], v[36:39], v[40:43], v[64:79]
    v_mfma_f32_32x32x16_bf16 v[80:95], v[36:39], v[44:47], v[80:95]
    s_waitcnt vmcnt(18)
    s_barrier
    s_lshl_b32 s41, s42, 7
    s_add_u32 s34, s43, s41
    s_lshl_b32 s35, s42, 16
    s_add_u32 m0, s36, 0
    s_nop 0
    buffer_load_dwordx4 v4, s[4:7], s34 offen lds
    s_add_u32 m0, s36, 1024
    s_nop 0
    buffer_load_dwordx4 v5, s[4:7], s34 offen lds
    s_add_u32 m0, s36, 2048
    s_nop 0
    buffer_load_dwordx4 v6, s[4:7], s34 offen lds
    s_add_u32 m0, s36, 3072
    s_nop 0
    buffer_load_dwordx4 v7, s[4:7], s34 offen lds
    s_add_u32 m0, s37, 0
    s_nop 0
    buffer_load_dwordx4 v14, s[8:11], s35 offen lds
    s_add_u32 m0, s37, 1024
    s_nop 0
    buffer_load_dwordx4 v15, s[8:11], s35 offen lds
    s_add_u32 s34, s34, 128
    s_add_u32 s35, s35, 0x10000
    s_cmp_eq_u32 s35, 0x180000
    s_cselect_b32 s41, 3072, 0
    s_cselect_b32 s35, 0, s35
    s_sub_u32 s34, s34, s41
    s_waitcnt lgkmcnt(0)
    ds_read_b128 v[36:39], v19 offset:24576
    ds_read_b64_tr_b16 v[40:41], v20 offset:30720
    ds_read_b64_tr_b16 v[42:43], v20 offset:31232
    ds_read_b64_tr_b16 v[44:45], v21 offset:30720
    ds_read_b64_tr_b16 v[46:47], v21 offset:31232
    v_mfma_f32_32x32x16_bf16 v[64:79], v[24:27], v[28:31], v[64:79]
    v_mfma_f32_32x32x16_bf16 v[80:95], v[24:27], v[32:35], v[80:95]
    s_waitcnt lgkmcnt(0)
    ds_read_b128 v[24:27], v48 offset:0
    ds_read_b64_tr_b16 v[28:29], v56 offset:0
    ds_read_b64_tr_b16 v[30:31], v56 offset:512
    ds_read_b64_tr_b16 v[32:33], v57 offset:0
    ds_read_b64_tr_b16 v[34:35], v57 offset:512
    v_mfma_f32_32x32x16_bf16 v[64:79], v[36:39], v[40:43], v[64:79]
    v_mfma_f32_32x32x16_bf16 v[80:95], v[36:39], v[44:47], v[80:95]
    s_waitcnt lgkmcnt(0)
    ds_read_b128 v[36:39], v49 offset:0
    ds_read_b64_tr_b16 v[40:41], v56 offset:2048
    ds_read_b64_tr_b16 v[42:43], v56 offset:2560
    ds_read_b64_tr_b16 v[44:45], v57 offset:2048
    ds_read_b64_tr_b16 v[46:47], v57 offset:2560
    v_mfma_f32_32x32x16_bf16 v[64:79], v[24:27], v[28:31], v[64:79]
    v_mfma_f32_32x32x16_bf16 v[80:95], v[24:27], v[32:35], v[80:95]
    s_waitcnt lgkmcnt(0)
    ds_read_b128 v[24:27], v50 offset:0
    ds_read_b64_tr_b16 v[28:29], v56 offset:4096
    ds_read_b64_tr_b16 v[30:31], v56 offset:4608
    ds_read_b64_tr_b16 v[32:33], v57 offset:4096
    ds_read_b64_tr_b16 v[34:35], v57 offset:4608
    v_mfma_f32_32x32x16_bf16 v[64:79], v[36:39], v[40:43], v[64:79]
    v_mfma_f32_32x32x16_bf16 v[80:95], v[36:39], v[44:47], v[80:95]
    s_waitcnt vmcnt(18)
    s_barrier
    s_lshl_b32 s41, s42, 7
    s_add_u32 s34, s43, s41
    s_add_u32 s34, s34, 2048
    s_lshl_b32 s35, s42, 16
    s_add_u32 s35, s35, 1048576
    s_add_u32 m0, s36, 24576
    s_nop 0
    buffer_load_dwordx4 v4, s[4:7], s34 offen lds
    s_add_u32 m0, s36, 25600
    s_nop 0
    buffer_load_dwordx4 v5, s[4:7], s34 offen lds
    s_add_u32 m0, s36, 26624
    s_nop 0
    buffer_load_dwordx4 v6, s[4:7], s34 offen lds
    s_add_u32 m0, s36, 27648
    s_nop 0
    buffer_load_dwordx4 v7, s[4:7], s34 offen lds
    s_add_u32 m0, s37, 24576
    s_nop 0
    buffer_load_dwordx4 v14, s[8:11], s35 offen lds
    s_add_u32 m0, s37, 25600
    s_nop 0
    buffer_load_dwordx4 v15, s[8:11], s35 offen lds
    s_add_u32 s34, s34, 128
    s_add_u32 s35, s35, 0x10000
    s_cmp_eq_u32 s35, 0x180000
    s_cselect_b32 s41, 3072, 0
    s_cselect_b32 s35, 0, s35
    s_sub_u32 s34, s34, s41
    s_waitcnt lgkmcnt(0)
    ds_read_b128 v[36:39], v51 offset:0
    ds_read_b64_tr_b16 v[40:41], v56 offset:6144
    ds_read_b64_tr_b16 v[42:43], v56 offset:6656
    ds_read_b64_tr_b16 v[44:45], v57 offset:6144
    ds_read_b64_tr_b16 v[46:47], v57 offset:6656
    v_mfma_f32_32x32x16_bf16 v[64:79], v[24:27], v[28:31], v[64:79]
    v_mfma_f32_32x32x16_bf16 v[80:95], v[24:27], v[32:35], v[80:95]
    s_waitcnt lgkmcnt(0)
    ds_read_b128 v[24:27], v48 offset:24576
    ds_read_b64_tr_b16 v[28:29], v56 offset:24576
    ds_read_b64_tr_b16 v[30:31], v56 offset:25088
    ds_read_b64_tr_b16 v[32:33], v57 offset:24576
    ds_read_b64_tr_b16 v[34:35], v57 offset:25088
    v_mfma_f32_32x32x16_bf16 v[64:79], v[36:39], v[40:43], v[64:79]
    v_mfma_f32_32x32x16_bf16 v[80:95], v[36:39], v[44:47], v[80:95]
    s_waitcnt lgkmcnt(0)
    ds_read_b128 v[36:39], v49 offset:24576
    ds_read_b64_tr_b16 v[40:41], v56 offset:26624
    ds_read_b64_tr_b16 v[42:43], v56 offset:27136
    ds_read_b64_tr_b16 v[44:45], v57 offset:26624
    ds_read_b64_tr_b16 v[46:47], v57 offset:27136
    v_mfma_f32_32x32x16_bf16 v[64:79], v[24:27], v[28:31], v[64:79]
    v_mfma_f32_32x32x16_bf16 v[80:95], v[24:27], v[32:35], v[80:95]
    s_waitcnt lgkmcnt(0)
    ds_read_b128 v[24:27], v50 offset:24576
    ds_read_b64_tr_b16 v[28:29], v56 offset:28672
    ds_read_b64_tr_b16 v[30:31], v56 offset:29184
    ds_read_b64_tr_b16 v[32:33], v57 offset:28672
    ds_read_b64_tr_b16 v[34:35], v57 offset:29184
    v_mfma_f32_32x32x16_bf16 v[64:79], v[36:39], v[40:43], v[64:79]
    v_mfma_f32_32x32x16_bf16 v[80:95], v[36:39], v[44:47], v[80:95]
    s_waitcnt vmcnt(18)
    s_barrier
    s_lshl_b32 s41, s42, 7
    s_add_u32 s34, s43, s41
    s_add_u32 s34, s34, 1024
    s_lshl_b32 s35, s42, 16
    s_add_u32 s35, s35, 524288
    s_add_u32 s42, s42, 1
    s_and_b32 s42, s42, 7
    s_add_u32 m0, s36, 49152
    s_nop 0
    buffer_load_dwordx4 v4, s[4:7], s34 offen lds
    s_add_u32 m0, s36, 50176
    s_nop 0
    buffer_load_dwordx4 v5, s[4:7], s34 offen lds
    s_add_u32 m0, s36, 51200
    s_nop 0
    buffer_load_dwordx4 v6, s[4:7], s34 offen lds
    s_add_u32 m0, s36, 52224
    s_nop 0
    buffer_load_dwordx4 v7, s[4:7], s34 offen lds
    s_add_u32 m0, s37, 49152
    s_nop 0
    buffer_load_dwordx4 v14, s[8:11], s35 offen lds
    s_add_u32 m0, s37, 50176
    s_nop 0
    buffer_load_dwordx4 v15, s[8:11], s35 offen lds
    s_add_u32 s34, s34, 128
    s_add_u32 s35, s35, 0x10000
    s_cmp_eq_u32 s35, 0x180000
    s_cselect_b32 s41, 3072, 0
    s_cselect_b32 s35, 0, s35
    s_sub_u32 s34, s34, s41
    s_waitcnt lgkmcnt(0)
    ds_read_b128 v[36:39], v51 offset:24576
    ds_read_b64_tr_b16 v[40:41], v56 offset:30720
    ds_read_b64_tr_b16 v[42:43], v56 offset:31232
    ds_read_b64_tr_b16 v[44:45], v57 offset:30720
    ds_read_b64_tr_b16 v[46:47], v57 offset:31232
    v_mfma_f32_32x32x16_bf16 v[64:79], v[24:27], v[28:31], v[64:79]
    v_mfma_f32_32x32x16_bf16 v[80:95], v[24:27], v[32:35], v[80:95]
    s_waitcnt lgkmcnt(0)
    ds_read_b128 v[24:27], v52 offset:0
    ds_read_b64_tr_b16 v[28:29], v58 offset:0
    ds_read_b64_tr_b16 v[30:31], v58 offset:512
    ds_read_b64_tr_b16 v[32:33], v59 offset:0
    ds_read_b64_tr_b16 v[34:35], v59 offset:512
    v_mfma_f32_32x32x16_bf16 v[64:79], v[36:39], v[40:43], v[64:79]
    v_mfma_f32_32x32x16_bf16 v[80:95], v[36:39], v[44:47], v[80:95]
    s_waitcnt lgkmcnt(0)
    ds_read_b128 v[36:39], v53 offset:0
    ds_read_b64_tr_b16 v[40:41], v58 offset:2048
    ds_read_b64_tr_b16 v[42:43], v58 offset:2560
    ds_read_b64_tr_b16 v[44:45], v59 offset:2048
    ds_read_b64_tr_b16 v[46:47], v59 offset:2560
    v_mfma_f32_32x32x16_bf16 v[64:79], v[24:27], v[28:31], v[64:79]
    v_mfma_f32_32x32x16_bf16 v[80:95], v[24:27], v[32:35], v[80:95]
    s_waitcnt lgkmcnt(0)
    ds_read_b128 v[24:27], v54 offset:0
    ds_read_b64_tr_b16 v[28:29], v58 offset:4096
    ds_read_b64_tr_b16 v[30:31], v58 offset:4608
    ds_read_b64_tr_b16 v[32:33], v59 offset:4096
    ds_read_b64_tr_b16 v[34:35], v59 offset:4608
    v_mfma_f32_32x32x16_bf16 v[64:79], v[36:39], v[40:43], v[64:79]
    v_mfma_f32_32x32x16_bf16 v[80:95], v[36:39], v[44:47], v[80:95]
    s_waitcnt vmcnt(18)
    s_barrier
    s_lshl_b32 s41, s42, 7
    s_add_u32 s34, s43, s41
    s_lshl_b32 s35, s42, 16
    s_add_u32 m0, s36, 73728
    s_nop 0
    buffer_load_dwordx4 v4, s[4:7], s34 offen lds
    s_add_u32 m0, s36, 74752
    s_nop 0
    buffer_load_dwordx4 v5, s[4:7], s34 offen lds
    s_add_u32 m0, s36, 75776
    s_nop 0
    buffer_load_dwordx4 v6, s[4:7], s34 offen lds
    s_add_u32 m0, s36, 76800
    s_nop 0
    buffer_load_dwordx4 v7, s[4:7], s34 offen lds
    s_add_u32 m0, s37, 73728
    s_nop 0
    buffer_load_dwordx4 v14, s[8:11], s35 offen lds
    s_add_u32 m0, s37, 74752
    s_nop 0
    buffer_load_dwordx4 v15, s[8:11], s35 offen lds
    s_add_u32 s34, s34, 128
    s_add_u32 s35, s35, 0x10000
    s_cmp_eq_u32 s35, 0x180000
    s_cselect_b32 s41, 3072, 0
    s_cselect_b32 s35, 0, s35
    s_sub_u32 s34, s34, s41
    s_waitcnt lgkmcnt(0)
    ds_read_b128 v[36:39], v55 offset:0
    ds_read_b64_tr_b16 v[40:41], v58 offset:6144
    ds_read_b64_tr_b16 v[42:43], v58 offset:6656
    ds_read_b64_tr_b16 v[44:45], v59 offset:6144
    ds_read_b64_tr_b16 v[46:47], v59 offset:6656
    v_mfma_f32_32x32x16_bf16 v[64:79], v[24:27], v[28:31], v[64:79]
    v_mfma_f32_32x32x16_bf16 v[80:95], v[24:27], v[32:35], v[80:95]
    s_waitcnt lgkmcnt(0)
    ds_read_b128 v[24:27], v52 offset:24576
    ds_read_b64_tr_b16 v[28:29], v58 offset:24576
    ds_read_b64_tr_b16 v[30:31], v58 offset:25088
    ds_read_b64_tr_b16 v[32:33], v59 offset:24576
    ds_read_b64_tr_b16 v[34:35], v59 offset:25088
    v_mfma_f32_32x32x16_bf16 v[64:79], v[36:39], v[40:43], v[64:79]
    v_mfma_f32_32x32x16_bf16 v[80:95], v[36:39], v[44:47], v[80:95]
    s_waitcnt lgkmcnt(0)
    ds_read_b128 v[36:39], v53 offset:24576
    ds_read_b64_tr_b16 v[40:41], v58 offset:26624
    ds_read_b64_tr_b16 v[42:43], v58 offset:27136
    ds_read_b64_tr_b16 v[44:45], v59 offset:26624
    ds_read_b64_tr_b16 v[46:47], v59 offset:27136
    v_mfma_f32_32x32x16_bf16 v[64:79], v[24:27], v[28:31], v[64:79]
    v_mfma_f32_32x32x16_bf16 v[80:95], v[24:27], v[32:35], v[80:95]
    s_waitcnt lgkmcnt(0)
    ds_read_b128 v[24:27], v54 offset:24576
    ds_read_b64_tr_b16 v[28:29], v58 offset:28672
    ds_read_b64_tr_b16 v[30:31], v58 offset:29184
    ds_read_b64_tr_b16 v[32:33], v59 offset:28672
    ds_read_b64_tr_b16 v[34:35], v59 offset:29184
    v_mfma_f32_32x32x16_bf16 v[64:79], v[36:39], v[40:43], v[64:79]
    v_mfma_f32_32x32x16_bf16 v[80:95], v[36:39], v[44:47], v[80:95]
    s_waitcnt vmcnt(18)
    s_barrier
    s_lshl_b32 s41, s42, 7
    s_add_u32 s34, s43, s41
    s_add_u32 s34, s34, 2048
    s_lshl_b32 s35, s42, 16
    s_add_u32 s35, s35, 1048576
    s_add_u32 m0, s36, 98304
    s_nop 0
    buffer_load_dwordx4 v4, s[4:7], s34 offen lds
    s_add_u32 m0, s36, 99328
    s_nop 0
    buffer_load_dwordx4 v5, s[4:7], s34 offen lds
    s_add_u32 m0, s36, 100352
    s_nop 0
    buffer_load_dwordx4 v6, s[4:7], s34 offen lds
    s_add_u32 m0, s36, 101376
    s_nop 0
    buffer_load_dwordx4 v7, s[4:7], s34 offen lds
    s_add_u32 m0, s37, 98304
    s_nop 0
    buffer_load_dwordx4 v14, s[8:11], s35 offen lds
    s_add_u32 m0, s37, 99328
    s_nop 0
    buffer_load_dwordx4 v15, s[8:11], s35 offen lds
    s_add_u32 s34, s34, 128
    s_add_u32 s35, s35, 0x10000
    s_cmp_eq_u32 s35, 0x180000
    s_cselect_b32 s41, 3072, 0
    s_cselect_b32 s35, 0, s35
    s_sub_u32 s34, s34, s41
    s_waitcnt lgkmcnt(0)
    ds_read_b128 v[36:39], v55 offset:24576
    ds_read_b64_tr_b16 v[40:41], v58 offset:30720
    ds_read_b64_tr_b16 v[42:43], v58 offset:31232
    ds_read_b64_tr_b16 v[44:45], v59 offset:30720
    ds_read_b64_tr_b16 v[46:47], v59 offset:31232
    v_mfma_f32_32x32x16_bf16 v[64:79], v[24:27], v[28:31], v[64:79]
    v_mfma_f32_32x32x16_bf16 v[80:95], v[24:27], v[32:35], v[80:95]
    s_waitcnt lgkmcnt(0)
    ds_read_b128 v[24:27], v16 offset:0
    ds_read_b64_tr_b16 v[28:29], v20 offset:0
    ds_read_b64_tr_b16 v[30:31], v20 offset:512
    ds_read_b64_tr_b16 v[32:33], v21 offset:0
    ds_read_b64_tr_b16 v[34:35], v21 offset:512
    v_mfma_f32_32x32x16_bf16 v[64:79], v[36:39], v[40:43], v[64:79]
    v_mfma_f32_32x32x16_bf16 v[80:95], v[36:39], v[44:47], v[80:95]
    s_waitcnt lgkmcnt(0)
    ds_read_b128 v[36:39], v17 offset:0
    ds_read_b64_tr_b16 v[40:41], v20 offset:2048
    ds_read_b64_tr_b16 v[42:43], v20 offset:2560
    ds_read_b64_tr_b16 v[44:45], v21 offset:2048
    ds_read_b64_tr_b16 v[46:47], v21 offset:2560
    v_mfma_f32_32x32x16_bf16 v[64:79], v[24:27], v[28:31], v[64:79]
    v_mfma_f32_32x32x16_bf16 v[80:95], v[24:27], v[32:35], v[80:95]
    s_waitcnt lgkmcnt(0)
    ds_read_b128 v[24:27], v18 offset:0
    ds_read_b64_tr_b16 v[28:29], v20 offset:4096
    ds_read_b64_tr_b16 v[30:31], v20 offset:4608
    ds_read_b64_tr_b16 v[32:33], v21 offset:4096
    ds_read_b64_tr_b16 v[34:35], v21 offset:4608
    v_mfma_f32_32x32x16_bf16 v[64:79], v[36:39], v[40:43], v[64:79]
    v_mfma_f32_32x32x16_bf16 v[80:95], v[36:39], v[44:47], v[80:95]
    s_waitcnt vmcnt(18)
    s_barrier
    s_lshl_b32 s41, s42, 7
    s_add_u32 s34, s43, s41
    s_add_u32 s34, s34, 1024
    s_lshl_b32 s35, s42, 16
    s_add_u32 s35, s35, 524288
    s_add_u32 s42, s42, 1
    s_and_b32 s42, s42, 7
    s_add_u32 m0, s36, 122880
    s_nop 0
    buffer_load_dwordx4 v4, s[4:7], s34 offen lds
    s_add_u32 m0, s36, 123904
    s_nop 0
    buffer_load_dwordx4 v5, s[4:7], s34 offen lds
    s_add_u32 m0, s36, 124928
    s_nop 0
    buffer_load_dwordx4 v6, s[4:7], s34 offen lds
    s_add_u32 m0, s36, 125952
    s_nop 0
    buffer_load_dwordx4 v7, s[4:7], s34 offen lds
    s_add_u32 m0, s37, 122880
    s_nop 0
    buffer_load_dwordx4 v14, s[8:11], s35 offen lds
    s_add_u32 m0, s37, 123904
    s_nop 0
    buffer_load_dwordx4 v15, s[8:11], s35 offen lds
    s_add_u32 s34, s34, 128
    s_add_u32 s35, s35, 0x10000
    s_cmp_eq_u32 s35, 0x180000
    s_cselect_b32 s41, 3072, 0
    s_cselect_b32 s35, 0, s35
    s_sub_u32 s34, s34, s41
    s_waitcnt lgkmcnt(0)
    ds_read_b128 v[36:39], v19 offset:0
    ds_read_b64_tr_b16 v[40:41], v20 offset:6144
    ds_read_b64_tr_b16 v[42:43], v20 offset:6656
    ds_read_b64_tr_b16 v[44:45], v21 offset:6144
    ds_read_b64_tr_b16 v[46:47], v21 offset:6656
    v_mfma_f32_32x32x16_bf16 v[64:79], v[24:27], v[28:31], v[64:79]
    v_mfma_f32_32x32x16_bf16 v[80:95], v[24:27], v[32:35], v[80:95]
    s_waitcnt lgkmcnt(0)
    ds_read_b128 v[24:27], v16 offset:24576
    ds_read_b64_tr_b16 v[28:29], v20 offset:24576
    ds_read_b64_tr_b16 v[30:31], v20 offset:25088
    ds_read_b64_tr_b16 v[32:33], v21 offset:24576
    ds_read_b64_tr_b16 v[34:35], v21 offset:25088
    v_mfma_f32_32x32x16_bf16 v[64:79], v[36:39], v[40:43], v[64:79]
    v_mfma_f32_32x32x16_bf16 v[80:95], v[36:39], v[44:47], v[80:95]
    s_waitcnt lgkmcnt(0)
    ds_read_b128 v[36:39], v17 offset:24576
    ds_read_b64_tr_b16 v[40:41], v20 offset:26624
    ds_read_b64_tr_b16 v[42:43], v20 offset:27136
    ds_read_b64_tr_b16 v[44:45], v21 offset:26624
    ds_read_b64_tr_b16 v[46:47], v21 offset:27136
    v_mfma_f32_32x32x16_bf16 v[64:79], v[24:27], v[28:31], v[64:79]
    v_mfma_f32_32x32x16_bf16 v[80:95], v[24:27], v[32:35], v[80:95]
    s_waitcnt lgkmcnt(0)
    ds_read_b128 v[24:27], v18 offset:24576
    ds_read_b64_tr_b16 v[28:29], v20 offset:28672
    ds_read_b64_tr_b16 v[30:31], v20 offset:29184
    ds_read_b64_tr_b16 v[32:33], v21 offset:28672
    ds_read_b64_tr_b16 v[34:35], v21 offset:29184
    v_mfma_f32_32x32x16_bf16 v[64:79], v[36:39], v[40:43], v[64:79]
    v_mfma_f32_32x32x16_bf16 v[80:95], v[36:39], v[44:47], v[80:95]
    s_waitcnt vmcnt(18)
    s_barrier
    s_waitcnt lgkmcnt(0)
    ds_read_b128 v[36:39], v19 offset:24576
    ds_read_b64_tr_b16 v[40:41], v20 offset:30720
    ds_read_b64_tr_b16 v[42:43], v20 offset:31232
    ds_read_b64_tr_b16 v[44:45], v21 offset:30720
    ds_read_b64_tr_b16 v[46:47], v21 offset:31232
    v_mfma_f32_32x32x16_bf16 v[64:79], v[24:27], v[28:31], v[64:79]
    v_mfma_f32_32x32x16_bf16 v[80:95], v[24:27], v[32:35], v[80:95]
    s_waitcnt lgkmcnt(0)
    ds_read_b128 v[24:27], v48 offset:0
    ds_read_b64_tr_b16 v[28:29], v56 offset:0
    ds_read_b64_tr_b16 v[30:31], v56 offset:512
    ds_read_b64_tr_b16 v[32:33], v57 offset:0
    ds_read_b64_tr_b16 v[34:35], v57 offset:512
    v_mfma_f32_32x32x16_bf16 v[64:79], v[36:39], v[40:43], v[64:79]
    v_mfma_f32_32x32x16_bf16 v[80:95], v[36:39], v[44:47], v[80:95]
    s_waitcnt lgkmcnt(0)
    ds_read_b128 v[36:39], v49 offset:0
    ds_read_b64_tr_b16 v[40:41], v56 offset:2048
    ds_read_b64_tr_b16 v[42:43], v56 offset:2560
    ds_read_b64_tr_b16 v[44:45], v57 offset:2048
    ds_read_b64_tr_b16 v[46:47], v57 offset:2560
    v_mfma_f32_32x32x16_bf16 v[64:79], v[24:27], v[28:31], v[64:79]
    v_mfma_f32_32x32x16_bf16 v[80:95], v[24:27], v[32:35], v[80:95]
    s_waitcnt lgkmcnt(0)
    ds_read_b128 v[24:27], v50 offset:0
    ds_read_b64_tr_b16 v[28:29], v56 offset:4096
    ds_read_b64_tr_b16 v[30:31], v56 offset:4608
    ds_read_b64_tr_b16 v[32:33], v57 offset:4096
    ds_read_b64_tr_b16 v[34:35], v57 offset:4608
    v_mfma_f32_32x32x16_bf16 v[64:79], v[36:39], v[40:43], v[64:79]
    v_mfma_f32_32x32x16_bf16 v[80:95], v[36:39], v[44:47], v[80:95]
    s_waitcnt vmcnt(12)
    s_barrier
    s_waitcnt lgkmcnt(0)
    ds_read_b128 v[36:39], v51 offset:0
    ds_read_b64_tr_b16 v[40:41], v56 offset:6144
    ds_read_b64_tr_b16 v[42:43], v56 offset:6656
    ds_read_b64_tr_b16 v[44:45], v57 offset:6144
    ds_read_b64_tr_b16 v[46:47], v57 offset:6656
    v_mfma_f32_32x32x16_bf16 v[64:79], v[24:27], v[28:31], v[64:79]
    v_mfma_f32_32x32x16_bf16 v[80:95], v[24:27], v[32:35], v[80:95]
    s_waitcnt lgkmcnt(0)
    ds_read_b128 v[24:27], v48 offset:24576
    ds_read_b64_tr_b16 v[28:29], v56 offset:24576
    ds_read_b64_tr_b16 v[30:31], v56 offset:25088
    ds_read_b64_tr_b16 v[32:33], v57 offset:24576
    ds_read_b64_tr_b16 v[34:35], v57 offset:25088
    v_mfma_f32_32x32x16_bf16 v[64:79], v[36:39], v[40:43], v[64:79]
    v_mfma_f32_32x32x16_bf16 v[80:95], v[36:39], v[44:47], v[80:95]
    s_waitcnt lgkmcnt(0)
    ds_read_b128 v[36:39], v49 offset:24576
    ds_read_b64_tr_b16 v[40:41], v56 offset:26624
    ds_read_b64_tr_b16 v[42:43], v56 offset:27136
    ds_read_b64_tr_b16 v[44:45], v57 offset:26624
    ds_read_b64_tr_b16 v[46:47], v57 offset:27136
    v_mfma_f32_32x32x16_bf16 v[64:79], v[24:27], v[28:31], v[64:79]
    v_mfma_f32_32x32x16_bf16 v[80:95], v[24:27], v[32:35], v[80:95]
    s_waitcnt lgkmcnt(0)
    ds_read_b128 v[24:27], v50 offset:24576
    ds_read_b64_tr_b16 v[28:29], v56 offset:28672
    ds_read_b64_tr_b16 v[30:31], v56 offset:29184
    ds_read_b64_tr_b16 v[32:33], v57 offset:28672
    ds_read_b64_tr_b16 v[34:35], v57 offset:29184
    v_mfma_f32_32x32x16_bf16 v[64:79], v[36:39], v[40:43], v[64:79]
    v_mfma_f32_32x32x16_bf16 v[80:95], v[36:39], v[44:47], v[80:95]
    s_waitcnt vmcnt(6)
    s_barrier
    s_waitcnt lgkmcnt(0)
    ds_read_b128 v[36:39], v51 offset:24576
    ds_read_b64_tr_b16 v[40:41], v56 offset:30720
    ds_read_b64_tr_b16 v[42:43], v56 offset:31232
    ds_read_b64_tr_b16 v[44:45], v57 offset:30720
    ds_read_b64_tr_b16 v[46:47], v57 offset:31232
    v_mfma_f32_32x32x16_bf16 v[64:79], v[24:27], v[28:31], v[64:79]
    v_mfma_f32_32x32x16_bf16 v[80:95], v[24:27], v[32:35], v[80:95]
    s_waitcnt lgkmcnt(0)
    ds_read_b128 v[24:27], v52 offset:0
    ds_read_b64_tr_b16 v[28:29], v58 offset:0
    ds_read_b64_tr_b16 v[30:31], v58 offset:512
    ds_read_b64_tr_b16 v[32:33], v59 offset:0
    ds_read_b64_tr_b16 v[34:35], v59 offset:512
    v_mfma_f32_32x32x16_bf16 v[64:79], v[36:39], v[40:43], v[64:79]
    v_mfma_f32_32x32x16_bf16 v[80:95], v[36:39], v[44:47], v[80:95]
    s_waitcnt lgkmcnt(0)
    ds_read_b128 v[36:39], v53 offset:0
    ds_read_b64_tr_b16 v[40:41], v58 offset:2048
    ds_read_b64_tr_b16 v[42:43], v58 offset:2560
    ds_read_b64_tr_b16 v[44:45], v59 offset:2048
    ds_read_b64_tr_b16 v[46:47], v59 offset:2560
    v_mfma_f32_32x32x16_bf16 v[64:79], v[24:27], v[28:31], v[64:79]
    v_mfma_f32_32x32x16_bf16 v[80:95], v[24:27], v[32:35], v[80:95]
    s_waitcnt lgkmcnt(0)
    ds_read_b128 v[24:27], v54 offset:0
    ds_read_b64_tr_b16 v[28:29], v58 offset:4096
    ds_read_b64_tr_b16 v[30:31], v58 offset:4608
    ds_read_b64_tr_b16 v[32:33], v59 offset:4096
    ds_read_b64_tr_b16 v[34:35], v59 offset:4608
    v_mfma_f32_32x32x16_bf16 v[64:79], v[36:39], v[40:43], v[64:79]
    v_mfma_f32_32x32x16_bf16 v[80:95], v[36:39], v[44:47], v[80:95]
    s_waitcnt vmcnt(0)
    s_barrier
    s_waitcnt lgkmcnt(0)
    ds_read_b128 v[36:39], v55 offset:0
    ds_read_b64_tr_b16 v[40:41], v58 offset:6144
    ds_read_b64_tr_b16 v[42:43], v58 offset:6656
    ds_read_b64_tr_b16 v[44:45], v59 offset:6144
    ds_read_b64_tr_b16 v[46:47], v59 offset:6656
    v_mfma_f32_32x32x16_bf16 v[64:79], v[24:27], v[28:31], v[64:79]
    v_mfma_f32_32x32x16_bf16 v[80:95], v[24:27], v[32:35], v[80:95]
    s_waitcnt lgkmcnt(0)
    ds_read_b128 v[24:27], v52 offset:24576
    ds_read_b64_tr_b16 v[28:29], v58 offset:24576
    ds_read_b64_tr_b16 v[30:31], v58 offset:25088
    ds_read_b64_tr_b16 v[32:33], v59 offset:24576
    ds_read_b64_tr_b16 v[34:35], v59 offset:25088
    v_mfma_f32_32x32x16_bf16 v[64:79], v[36:39], v[40:43], v[64:79]
    v_mfma_f32_32x32x16_bf16 v[80:95], v[36:39], v[44:47], v[80:95]
    s_waitcnt lgkmcnt(0)
    ds_read_b128 v[36:39], v53 offset:24576
    ds_read_b64_tr_b16 v[40:41], v58 offset:26624
    ds_read_b64_tr_b16 v[42:43], v58 offset:27136
    ds_read_b64_tr_b16 v[44:45], v59 offset:26624
    ds_read_b64_tr_b16 v[46:47], v59 offset:27136
    v_mfma_f32_32x32x16_bf16 v[64:79], v[24:27], v[28:31], v[64:79]
    v_mfma_f32_32x32x16_bf16 v[80:95], v[24:27], v[32:35], v[80:95]
    s_waitcnt lgkmcnt(0)
    ds_read_b128 v[24:27], v54 offset:24576
    ds_read_b64_tr_b16 v[28:29], v58 offset:28672
    ds_read_b64_tr_b16 v[30:31], v58 offset:29184
    ds_read_b64_tr_b16 v[32:33], v59 offset:28672
    ds_read_b64_tr_b16 v[34:35], v59 offset:29184
    v_mfma_f32_32x32x16_bf16 v[64:79], v[36:39], v[40:43], v[64:79]
    v_mfma_f32_32x32x16_bf16 v[80:95], v[36:39], v[44:47], v[80:95]
    s_waitcnt lgkmcnt(0)
    ds_read_b128 v[36:39], v55 offset:24576
    ds_read_b64_tr_b16 v[40:41], v58 offset:30720
    ds_read_b64_tr_b16 v[42:43], v58 offset:31232
    ds_read_b64_tr_b16 v[44:45], v59 offset:30720
    ds_read_b64_tr_b16 v[46:47], v59 offset:31232
    v_mfma_f32_32x32x16_bf16 v[64:79], v[24:27], v[28:31], v[64:79]
    v_mfma_f32_32x32x16_bf16 v[80:95], v[24:27], v[32:35], v[80:95]
    s_waitcnt lgkmcnt(0)
    v_mfma_f32_32x32x16_bf16 v[64:79], v[36:39], v[40:43], v[64:79]
    v_mfma_f32_32x32x16_bf16 v[80:95], v[36:39], v[44:47], v[80:95]
    s_waitcnt vmcnt(0) lgkmcnt(0)
    s_barrier
    v_and_b32 v8, 31, v1
    s_lshl_b32 s33, s21, 7
    v_lshl_add_u32 v9, v8, 1, s33
    buffer_load_ushort v24, v9, s[16:19], 0 offen
    buffer_load_ushort v25, v9, s[16:19], 0 offen offset:64
    s_lshl_b32 s33, s23, 7
    s_lshl_b32 s38, s32, 5
    s_add_u32 s33, s33, s38
    s_sub_u32 s33, 1999, s33
    v_lshrrev_b32 v10, 5, v1
    v_lshlrev_b32 v10, 2, v10
    v_sub_u32 v10, s33, v10
    s_nop 7
    v_mov_b32 v26, 0
    v_mov_b32 v27, 0
    v_mov_b32 v28, 0
    v_mov_b32 v29, 0
    v_cmp_lt_i32 vcc, 0, v10
    s_nop 1
    v_cndmask_b32 v11, 0, v64, vcc
    v_add_f32 v26, v26, v11
    v_fmac_f32 v27, v11, v11
    v_cndmask_b32 v11, 0, v80, vcc
    v_add_f32 v28, v28, v11
    v_fmac_f32 v29, v11, v11
    v_cmp_lt_i32 vcc, 1, v10
    s_nop 1
    v_cndmask_b32 v11, 0, v65, vcc
    v_add_f32 v26, v26, v11
    v_fmac_f32 v27, v11, v11
    v_cndmask_b32 v11, 0, v81, vcc
    v_add_f32 v28, v28, v11
    v_fmac_f32 v29, v11, v11
    v_cmp_lt_i32 vcc, 2, v10
    s_nop 1
    v_cndmask_b32 v11, 0, v66, vcc
    v_add_f32 v26, v26, v11
    v_fmac_f32 v27, v11, v11
    v_cndmask_b32 v11, 0, v82, vcc
    v_add_f32 v28, v28, v11
    v_fmac_f32 v29, v11, v11
    v_cmp_lt_i32 vcc, 3, v10
    s_nop 1
    v_cndmask_b32 v11, 0, v67, vcc
    v_add_f32 v26, v26, v11
    v_fmac_f32 v27, v11, v11
    v_cndmask_b32 v11, 0, v83, vcc
    v_add_f32 v28, v28, v11
    v_fmac_f32 v29, v11, v11
    v_cmp_lt_i32 vcc, 8, v10
    s_nop 1
    v_cndmask_b32 v11, 0, v68, vcc
    v_add_f32 v26, v26, v11
    v_fmac_f32 v27, v11, v11
    v_cndmask_b32 v11, 0, v84, vcc
    v_add_f32 v28, v28, v11
    v_fmac_f32 v29, v11, v11
    v_cmp_lt_i32 vcc, 9, v10
    s_nop 1
    v_cndmask_b32 v11, 0, v69, vcc
    v_add_f32 v26, v26, v11
    v_fmac_f32 v27, v11, v11
    v_cndmask_b32 v11, 0, v85, vcc
    v_add_f32 v28, v28, v11
    v_fmac_f32 v29, v11, v11
    v_cmp_lt_i32 vcc, 10, v10
    s_nop 1
    v_cndmask_b32 v11, 0, v70, vcc
    v_add_f32 v26, v26, v11
    v_fmac_f32 v27, v11, v11
    v_cndmask_b32 v11, 0, v86, vcc
    v_add_f32 v28, v28, v11
    v_fmac_f32 v29, v11, v11
    v_cmp_lt_i32 vcc, 11, v10
    s_nop 1
    v_cndmask_b32 v11, 0, v71, vcc
    v_add_f32 v26, v26, v11
    v_fmac_f32 v27, v11, v11
    v_cndmask_b32 v11, 0, v87, vcc
    v_add_f32 v28, v28, v11
    v_fmac_f32 v29, v11, v11
    v_cmp_lt_i32 vcc, 16, v10
    s_nop 1
    v_cndmask_b32 v11, 0, v72, vcc
    v_add_f32 v26, v26, v11
    v_fmac_f32 v27, v11, v11
    v_cndmask_b32 v11, 0, v88, vcc
    v_add_f32 v28, v28, v11
    v_fmac_f32 v29, v11, v11
    v_cmp_lt_i32 vcc, 17, v10
    s_nop 1
    v_cndmask_b32 v11, 0, v73, vcc
    v_add_f32 v26, v26, v11
    v_fmac_f32 v27, v11, v11
    v_cndmask_b32 v11, 0, v89, vcc
    v_add_f32 v28, v28, v11
    v_fmac_f32 v29, v11, v11
    v_cmp_lt_i32 vcc, 18, v10
    s_nop 1
    v_cndmask_b32 v11, 0, v74, vcc
    v_add_f32 v26, v26, v11
    v_fmac_f32 v27, v11, v11
    v_cndmask_b32 v11, 0, v90, vcc
    v_add_f32 v28, v28, v11
    v_fmac_f32 v29, v11, v11
    v_cmp_lt_i32 vcc, 19, v10
    s_nop 1
    v_cndmask_b32 v11, 0, v75, vcc
    v_add_f32 v26, v26, v11
    v_fmac_f32 v27, v11, v11
    v_cndmask_b32 v11, 0, v91, vcc
    v_add_f32 v28, v28, v11
    v_fmac_f32 v29, v11, v11
    v_cmp_lt_i32 vcc, 24, v10
    s_nop 1
    v_cndmask_b32 v11, 0, v76, vcc
    v_add_f32 v26, v26, v11
    v_fmac_f32 v27, v11, v11
    v_cndmask_b32 v11, 0, v92, vcc
    v_add_f32 v28, v28, v11
    v_fmac_f32 v29, v11, v11
    v_cmp_lt_i32 vcc, 25, v10
    s_nop 1
    v_cndmask_b32 v11, 0, v77, vcc
    v_add_f32 v26, v26, v11
    v_fmac_f32 v27, v11, v11
    v_cndmask_b32 v11, 0, v93, vcc
    v_add_f32 v28, v28, v11
    v_fmac_f32 v29, v11, v11
    v_cmp_lt_i32 vcc, 26, v10
    s_nop 1
    v_cndmask_b32 v11, 0, v78, vcc
    v_add_f32 v26, v26, v11
    v_fmac_f32 v27, v11, v11
    v_cndmask_b32 v11, 0, v94, vcc
    v_add_f32 v28, v28, v11
    v_fmac_f32 v29, v11, v11
    v_cmp_lt_i32 vcc, 27, v10
    s_nop 1
    v_cndmask_b32 v11, 0, v79, vcc
    v_add_f32 v26, v26, v11
    v_fmac_f32 v27, v11, v11
    v_cndmask_b32 v11, 0, v95, vcc
    v_add_f32 v28, v28, v11
    v_fmac_f32 v29, v11, v11
    v_lshlrev_b32 v11, 3, v1
    s_lshl_b32 s38, s32, 10
    v_add_u32 v11, s38, v11
    ds_write_b64 v11, v[26:27]
    ds_write_b64 v11, v[28:29] offset:512
    s_waitcnt vmcnt(0)
    v_lshlrev_b32 v24, 16, v24
    v_lshlrev_b32 v25, 16, v25
    v_lshrrev_b32 v12, 5, v1
    v_lshlrev_b32 v12, 9, v12
    v_lshl_add_u32 v12, v8, 1, v12
    s_lshl_b32 s38, s32, 12
    s_add_u32 s38, s38, 8192
    v_add_u32 v12, s38, v12
    v_add_f32 v64, v64, v24
    v_add_f32 v65, v65, v24
    v_cvt_pk_bf16_f32 v64, v64, v65
    ds_write_b16 v12, v64 offset:0
    ds_write_b16_d16_hi v12, v64 offset:128
    v_add_f32 v66, v66, v24
    v_add_f32 v67, v67, v24
    v_cvt_pk_bf16_f32 v66, v66, v67
    ds_write_b16 v12, v66 offset:256
    ds_write_b16_d16_hi v12, v66 offset:384
    v_add_f32 v68, v68, v24
    v_add_f32 v69, v69, v24
    v_cvt_pk_bf16_f32 v68, v68, v69
    ds_write_b16 v12, v68 offset:1024
    ds_write_b16_d16_hi v12, v68 offset:1152
    v_add_f32 v70, v70, v24
    v_add_f32 v71, v71, v24
    v_cvt_pk_bf16_f32 v70, v70, v71
    ds_write_b16 v12, v70 offset:1280
    ds_write_b16_d16_hi v12, v70 offset:1408
    v_add_f32 v72, v72, v24
    v_add_f32 v73, v73, v24
    v_cvt_pk_bf16_f32 v72, v72, v73
    ds_write_b16 v12, v72 offset:2048
    ds_write_b16_d16_hi v12, v72 offset:2176
    v_add_f32 v74, v74, v24
    v_add_f32 v75, v75, v24
    v_cvt_pk_bf16_f32 v74, v74, v75
    ds_write_b16 v12, v74 offset:2304
    ds_write_b16_d16_hi v12, v74 offset:2432
    v_add_f32 v76, v76, v24
    v_add_f32 v77, v77, v24
    v_cvt_pk_bf16_f32 v76, v76, v77
    ds_write_b16 v12, v76 offset:3072
    ds_write_b16_d16_hi v12, v76 offset:3200
    v_add_f32 v78, v78, v24
    v_add_f32 v79, v79, v24
    v_cvt_pk_bf16_f32 v78, v78, v79
    ds_write_b16 v12, v78 offset:3328
    ds_write_b16_d16_hi v12, v78 offset:3456
    v_add_f32 v80, v80, v25
    v_add_f32 v81, v81, v25
    v_cvt_pk_bf16_f32 v80, v80, v81
    ds_write_b16 v12, v80 offset:64
    ds_write_b16_d16_hi v12, v80 offset:192
    v_add_f32 v82, v82, v25
    v_add_f32 v83, v83, v25
    v_cvt_pk_bf16_f32 v82, v82, v83
    ds_write_b16 v12, v82 offset:320
    ds_write_b16_d16_hi v12, v82 offset:448
    v_add_f32 v84, v84, v25
    v_add_f32 v85, v85, v25
    v_cvt_pk_bf16_f32 v84, v84, v85
    ds_write_b16 v12, v84 offset:1088
    ds_write_b16_d16_hi v12, v84 offset:1216
    v_add_f32 v86, v86, v25
    v_add_f32 v87, v87, v25
    v_cvt_pk_bf16_f32 v86, v86, v87
    ds_write_b16 v12, v86 offset:1344
    ds_write_b16_d16_hi v12, v86 offset:1472
    v_add_f32 v88, v88, v25
    v_add_f32 v89, v89, v25
    v_cvt_pk_bf16_f32 v88, v88, v89
    ds_write_b16 v12, v88 offset:2112
    ds_write_b16_d16_hi v12, v88 offset:2240
    v_add_f32 v90, v90, v25
    v_add_f32 v91, v91, v25
    v_cvt_pk_bf16_f32 v90, v90, v91
    ds_write_b16 v12, v90 offset:2368
    ds_write_b16_d16_hi v12, v90 offset:2496
    v_add_f32 v92, v92, v25
    v_add_f32 v93, v93, v25
    v_cvt_pk_bf16_f32 v92, v92, v93
    ds_write_b16 v12, v92 offset:3136
    ds_write_b16_d16_hi v12, v92 offset:3264
    v_add_f32 v94, v94, v25
    v_add_f32 v95, v95, v25
    v_cvt_pk_bf16_f32 v94, v94, v95
    ds_write_b16 v12, v94 offset:3392
    ds_write_b16_d16_hi v12, v94 offset:3520
    s_waitcnt lgkmcnt(0)
    s_barrier
    v_lshrrev_b32 v13, 3, v1
    v_and_b32 v14, 7, v1
    v_lshlrev_b32 v15, 7, v13
    v_lshl_add_u32 v15, v14, 4, v15
    v_add_u32 v15, s38, v15
    ds_read_b128 v[32:35], v15 offset:0
    ds_read_b128 v[36:39], v15 offset:1024
    ds_read_b128 v[40:43], v15 offset:2048
    ds_read_b128 v[44:47], v15 offset:3072
    s_lshl_b32 s33, s22, 11
    s_lshl_b32 s39, s23, 7
    s_add_u32 s33, s33, s39
    s_lshl_b32 s39, s32, 5
    s_add_u32 s33, s33, s39
    s_lshl_b32 s33, s33, 10
    s_lshl_b32 s39, s21, 7
    s_add_u32 s33, s33, s39
    v_lshlrev_b32 v15, 10, v13
    v_lshl_add_u32 v15, v14, 4, v15
    v_add_u32 v15, s33, v15
    s_waitcnt lgkmcnt(3)
    s_mov_b32 s39, 0
    buffer_store_dwordx4 v[32:35], v15, s[12:15], s39 offen
    s_waitcnt lgkmcnt(2)
    s_mov_b32 s39, 8192
    buffer_store_dwordx4 v[36:39], v15, s[12:15], s39 offen
    s_waitcnt lgkmcnt(1)
    s_mov_b32 s39, 16384
    buffer_store_dwordx4 v[40:43], v15, s[12:15], s39 offen
    s_waitcnt lgkmcnt(0)
    s_mov_b32 s39, 24576
    buffer_store_dwordx4 v[44:47], v15, s[12:15], s39 offen
    s_cmp_lg_u32 s32, 0
    s_cbranch_scc1 L_k1_end
    v_lshrrev_b32 v11, 5, v1
    v_lshlrev_b32 v11, 9, v11
    v_lshl_add_u32 v11, v8, 3, v11
    ds_read_b64 v[40:41], v11 offset:0
    ds_read_b64 v[42:43], v11 offset:256
    ds_read_b64 v[44:45], v11 offset:1024
    ds_read_b64 v[46:47], v11 offset:1280
    ds_read_b64 v[48:49], v11 offset:2048
    ds_read_b64 v[50:51], v11 offset:2304
    ds_read_b64 v[52:53], v11 offset:3072
    ds_read_b64 v[54:55], v11 offset:3328
    s_waitcnt lgkmcnt(0)
    v_add_f32 v40, v40, v42
    v_add_f32 v41, v41, v43
    v_add_f32 v40, v40, v44
    v_add_f32 v41, v41, v45
    v_add_f32 v40, v40, v46
    v_add_f32 v41, v41, v47
    v_add_f32 v40, v40, v48
    v_add_f32 v41, v41, v49
    v_add_f32 v40, v40, v50
    v_add_f32 v41, v41, v51
    v_add_f32 v40, v40, v52
    v_add_f32 v41, v41, v53
    v_add_f32 v40, v40, v54
    v_add_f32 v41, v41, v55
    s_lshl_b32 s33, s20, 9
    s_lshl_b32 s39, s21, 6
    s_add_u32 s33, s33, s39
    s_lshl_b32 s33, s33, 3
    s_add_u32 s33, s33, 4194304
    v_lshl_add_u32 v11, v1, 3, s33
    buffer_store_dwordx2 v[40:41], v11, s[12:15], 0 offen
L_k1_end:
    s_endpgm
.globl norm_gelu_kernel
.p2align 8
.type norm_gelu_kernel,@function
norm_gelu_kernel:
    s_cmp_ge_u32 s2, 256
    s_cbranch_scc1 L_k2_end
    s_load_dwordx4 s[24:27], s[0:1], 16
    s_load_dwordx4 s[28:31], s[0:1], 32
    s_load_dwordx2 s[32:33], s[0:1], 56
    s_and_b32 s20, s2, 31
    s_lshr_b32 s21, s2, 5
    s_lshr_b32 s22, s20, 4
    s_and_b32 s23, s20, 15
    v_and_b32 v1, 63, v0
    v_lshrrev_b32 v2, 3, v0
    v_and_b32 v3, 7, v0
    s_waitcnt lgkmcnt(0)
    s_mov_b32 s4, s32
    s_and_b32 s5, s33, 0xffff
    s_mov_b32 s6, 268435456
    s_mov_b32 s7, 0x00020000
    s_mov_b32 s8, s30
    s_and_b32 s9, s31, 0xffff
    s_mov_b32 s10, 4093952
    s_mov_b32 s11, 0x00020000
    s_mov_b32 s12, s24
    s_and_b32 s13, s25, 0xffff
    s_mov_b32 s14, 1024
    s_mov_b32 s15, 0x00020000
    s_mov_b32 s16, s26
    s_and_b32 s17, s27, 0xffff
    s_mov_b32 s18, 1024
    s_mov_b32 s19, 0x00020000
    s_mov_b32 s40, s28
    s_and_b32 s41, s29, 0xffff
    s_mov_b32 s42, 1024
    s_mov_b32 s43, 0x00020000
    s_lshl_b32 s33, s22, 11
    s_lshl_b32 s39, s23, 7
    s_add_u32 s33, s33, s39
    s_lshl_b32 s33, s33, 10
    s_lshl_b32 s39, s21, 7
    s_add_u32 s33, s33, s39
    v_lshlrev_b32 v4, 10, v2
    v_lshl_add_u32 v4, v3, 4, v4
    v_add_u32 v4, s33, v4
    buffer_load_dwordx4 v[16:19], v4, s[4:7], 0 offen offset:0
    v_add_u32 v5, 32768, v4
    buffer_load_dwordx4 v[20:23], v5, s[4:7], 0 offen
    v_add_u32 v5, 65536, v4
    buffer_load_dwordx4 v[24:27], v5, s[4:7], 0 offen
    v_add_u32 v5, 98304, v4
    buffer_load_dwordx4 v[28:31], v5, s[4:7], 0 offen
    s_lshl_b32 s33, s22, 13
    s_lshl_b32 s39, s21, 6
    s_add_u32 s33, s33, s39
    s_lshl_b32 s33, s33, 3
    s_add_u32 s33, s33, 4194304
    v_lshl_add_u32 v6, v1, 3, s33
    buffer_load_dwordx2 v[32:33], v6, s[4:7], 0 offen offset:0
    v_add_u32 v7, 4096, v6
    buffer_load_dwordx2 v[34:35], v7, s[4:7], 0 offen
    v_add_u32 v7, 8192, v6
    buffer_load_dwordx2 v[36:37], v7, s[4:7], 0 offen
    v_add_u32 v7, 12288, v6
    buffer_load_dwordx2 v[38:39], v7, s[4:7], 0 offen
    v_add_u32 v7, 16384, v6
    buffer_load_dwordx2 v[40:41], v7, s[4:7], 0 offen
    v_add_u32 v7, 20480, v6
    buffer_load_dwordx2 v[42:43], v7, s[4:7], 0 offen
    v_add_u32 v7, 24576, v6
    buffer_load_dwordx2 v[44:45], v7, s[4:7], 0 offen
    v_add_u32 v7, 28672, v6
    buffer_load_dwordx2 v[46:47], v7, s[4:7], 0 offen
    v_add_u32 v7, 32768, v6
    buffer_load_dwordx2 v[48:49], v7, s[4:7], 0 offen
    v_add_u32 v7, 36864, v6
    buffer_load_dwordx2 v[50:51], v7, s[4:7], 0 offen
    v_add_u32 v7, 40960, v6
    buffer_load_dwordx2 v[52:53], v7, s[4:7], 0 offen
    v_add_u32 v7, 45056, v6
    buffer_load_dwordx2 v[54:55], v7, s[4:7], 0 offen
    v_add_u32 v7, 49152, v6
    buffer_load_dwordx2 v[56:57], v7, s[4:7], 0 offen
    v_add_u32 v7, 53248, v6
    buffer_load_dwordx2 v[58:59], v7, s[4:7], 0 offen
    v_add_u32 v7, 57344, v6
    buffer_load_dwordx2 v[60:61], v7, s[4:7], 0 offen
    v_add_u32 v7, 61440, v6
    buffer_load_dwordx2 v[62:63], v7, s[4:7], 0 offen
    s_lshl_b32 s39, s21, 7
    v_lshl_add_u32 v8, v1, 1, s39
    buffer_load_ushort v9, v8, s[12:15], 0 offen
    buffer_load_ushort v10, v8, s[16:19], 0 offen
    buffer_load_ushort v11, v8, s[40:43], 0 offen
    s_waitcnt vmcnt(3)
    v_add_f32 v32, v32, v34
    v_add_f32 v33, v33, v35
    v_add_f32 v32, v32, v36
    v_add_f32 v33, v33, v37
    v_add_f32 v32, v32, v38
    v_add_f32 v33, v33, v39
    v_add_f32 v32, v32, v40
    v_add_f32 v33, v33, v41
    v_add_f32 v32, v32, v42
    v_add_f32 v33, v33, v43
    v_add_f32 v32, v32, v44
    v_add_f32 v33, v33, v45
    v_add_f32 v32, v32, v46
    v_add_f32 v33, v33, v47
    v_add_f32 v32, v32, v48
    v_add_f32 v33, v33, v49
    v_add_f32 v32, v32, v50
    v_add_f32 v33, v33, v51
    v_add_f32 v32, v32, v52
    v_add_f32 v33, v33, v53
    v_add_f32 v32, v32, v54
    v_add_f32 v33, v33, v55
    v_add_f32 v32, v32, v56
    v_add_f32 v33, v33, v57
    v_add_f32 v32, v32, v58
    v_add_f32 v33, v33, v59
    v_add_f32 v32, v32, v60
    v_add_f32 v33, v33, v61
    v_add_f32 v32, v32, v62
    v_add_f32 v33, v33, v63
    v_mov_b32 v12, 0x3a032338
    v_mul_f32 v32, v32, v12
    v_mul_f32 v33, v33, v12
    v_fma_f32 v33, -v32, v32, v33
    v_max_f32 v33, 0, v33
    v_add_f32 v33, 0x3727c5ac, v33
    v_rsq_f32 v33, v33
    s_waitcnt vmcnt(0)
    v_lshlrev_b32 v9, 16, v9
    v_lshlrev_b32 v10, 16, v10
    v_lshlrev_b32 v11, 16, v11
    v_add_f32 v32, v32, v9
    v_mul_f32 v33, v33, v10
    v_mov_b32 v34, v11
    v_mov_b32 v35, 0
    v_lshlrev_b32 v12, 4, v1
    ds_write_b128 v12, v[32:35]
    s_waitcnt lgkmcnt(0)
    s_barrier
    v_lshlrev_b32 v12, 7, v3
    ds_read_b128 v[32:35], v12 offset:0
    ds_read_b128 v[36:39], v12 offset:16
    ds_read_b128 v[40:43], v12 offset:32
    ds_read_b128 v[44:47], v12 offset:48
    ds_read_b128 v[48:51], v12 offset:64
    ds_read_b128 v[52:55], v12 offset:80
    ds_read_b128 v[56:59], v12 offset:96
    ds_read_b128 v[60:63], v12 offset:112
    s_waitcnt lgkmcnt(0)
    v_mov_b32 v14, 0x3d372713
    v_mov_b32 v15, 0xc0135761
    s_lshl_b32 s39, s23, 7
    v_add_u32 v13, s39, v2
    s_mul_i32 s33, s22, 1999
    s_lshl_b32 s33, s33, 10
    s_lshl_b32 s39, s21, 7
    s_add_u32 s33, s33, s39
    v_lshlrev_b32 v4, 10, v13
    v_lshl_add_u32 v4, v3, 4, v4
    v_add_u32 v4, s33, v4
    v_lshlrev_b32 v64, 16, v16
    v_sub_f32 v64, v64, v32
    v_fma_f32 v64, v64, v33, v34
    v_mul_f32 v66, v64, v64
    v_fma_f32 v66, v66, v14, 1.0
    v_mul_f32 v66, v66, v64
    v_mul_f32 v66, v66, v15
    v_exp_f32 v66, v66
    s_nop 0
    v_add_f32 v66, 1.0, v66
    v_rcp_f32 v66, v66
    s_nop 0
    v_mul_f32 v64, v64, v66
    v_and_b32 v65, 0xffff0000, v16
    v_sub_f32 v65, v65, v36
    v_fma_f32 v65, v65, v37, v38
    v_mul_f32 v67, v65, v65
    v_fma_f32 v67, v67, v14, 1.0
    v_mul_f32 v67, v67, v65
    v_mul_f32 v67, v67, v15
    v_exp_f32 v67, v67
    s_nop 0
    v_add_f32 v67, 1.0, v67
    v_rcp_f32 v67, v67
    s_nop 0
    v_mul_f32 v65, v65, v67
    v_cvt_pk_bf16_f32 v16, v64, v65
    v_lshlrev_b32 v64, 16, v17
    v_sub_f32 v64, v64, v40
    v_fma_f32 v64, v64, v41, v42
    v_mul_f32 v66, v64, v64
    v_fma_f32 v66, v66, v14, 1.0
    v_mul_f32 v66, v66, v64
    v_mul_f32 v66, v66, v15
    v_exp_f32 v66, v66
    s_nop 0
    v_add_f32 v66, 1.0, v66
    v_rcp_f32 v66, v66
    s_nop 0
    v_mul_f32 v64, v64, v66
    v_and_b32 v65, 0xffff0000, v17
    v_sub_f32 v65, v65, v44
    v_fma_f32 v65, v65, v45, v46
    v_mul_f32 v67, v65, v65
    v_fma_f32 v67, v67, v14, 1.0
    v_mul_f32 v67, v67, v65
    v_mul_f32 v67, v67, v15
    v_exp_f32 v67, v67
    s_nop 0
    v_add_f32 v67, 1.0, v67
    v_rcp_f32 v67, v67
    s_nop 0
    v_mul_f32 v65, v65, v67
    v_cvt_pk_bf16_f32 v17, v64, v65
    v_lshlrev_b32 v64, 16, v18
    v_sub_f32 v64, v64, v48
    v_fma_f32 v64, v64, v49, v50
    v_mul_f32 v66, v64, v64
    v_fma_f32 v66, v66, v14, 1.0
    v_mul_f32 v66, v66, v64
    v_mul_f32 v66, v66, v15
    v_exp_f32 v66, v66
    s_nop 0
    v_add_f32 v66, 1.0, v66
    v_rcp_f32 v66, v66
    s_nop 0
    v_mul_f32 v64, v64, v66
    v_and_b32 v65, 0xffff0000, v18
    v_sub_f32 v65, v65, v52
    v_fma_f32 v65, v65, v53, v54
    v_mul_f32 v67, v65, v65
    v_fma_f32 v67, v67, v14, 1.0
    v_mul_f32 v67, v67, v65
    v_mul_f32 v67, v67, v15
    v_exp_f32 v67, v67
    s_nop 0
    v_add_f32 v67, 1.0, v67
    v_rcp_f32 v67, v67
    s_nop 0
    v_mul_f32 v65, v65, v67
    v_cvt_pk_bf16_f32 v18, v64, v65
    v_lshlrev_b32 v64, 16, v19
    v_sub_f32 v64, v64, v56
    v_fma_f32 v64, v64, v57, v58
    v_mul_f32 v66, v64, v64
    v_fma_f32 v66, v66, v14, 1.0
    v_mul_f32 v66, v66, v64
    v_mul_f32 v66, v66, v15
    v_exp_f32 v66, v66
    s_nop 0
    v_add_f32 v66, 1.0, v66
    v_rcp_f32 v66, v66
    s_nop 0
    v_mul_f32 v64, v64, v66
    v_and_b32 v65, 0xffff0000, v19
    v_sub_f32 v65, v65, v60
    v_fma_f32 v65, v65, v61, v62
    v_mul_f32 v67, v65, v65
    v_fma_f32 v67, v67, v14, 1.0
    v_mul_f32 v67, v67, v65
    v_mul_f32 v67, v67, v15
    v_exp_f32 v67, v67
    s_nop 0
    v_add_f32 v67, 1.0, v67
    v_rcp_f32 v67, v67
    s_nop 0
    v_mul_f32 v65, v65, v67
    v_cvt_pk_bf16_f32 v19, v64, v65
    v_cmp_gt_i32 vcc, 1999, v13
    s_and_saveexec_b64 s[44:45], vcc
    buffer_store_dwordx4 v[16:19], v4, s[8:11], 0 offen offset:0
    s_mov_b64 exec, s[44:45]
    v_add_u32 v5, 32768, v4
    v_lshlrev_b32 v64, 16, v20
    v_sub_f32 v64, v64, v32
    v_fma_f32 v64, v64, v33, v34
    v_mul_f32 v66, v64, v64
    v_fma_f32 v66, v66, v14, 1.0
    v_mul_f32 v66, v66, v64
    v_mul_f32 v66, v66, v15
    v_exp_f32 v66, v66
    s_nop 0
    v_add_f32 v66, 1.0, v66
    v_rcp_f32 v66, v66
    s_nop 0
    v_mul_f32 v64, v64, v66
    v_and_b32 v65, 0xffff0000, v20
    v_sub_f32 v65, v65, v36
    v_fma_f32 v65, v65, v37, v38
    v_mul_f32 v67, v65, v65
    v_fma_f32 v67, v67, v14, 1.0
    v_mul_f32 v67, v67, v65
    v_mul_f32 v67, v67, v15
    v_exp_f32 v67, v67
    s_nop 0
    v_add_f32 v67, 1.0, v67
    v_rcp_f32 v67, v67
    s_nop 0
    v_mul_f32 v65, v65, v67
    v_cvt_pk_bf16_f32 v20, v64, v65
    v_lshlrev_b32 v64, 16, v21
    v_sub_f32 v64, v64, v40
    v_fma_f32 v64, v64, v41, v42
    v_mul_f32 v66, v64, v64
    v_fma_f32 v66, v66, v14, 1.0
    v_mul_f32 v66, v66, v64
    v_mul_f32 v66, v66, v15
    v_exp_f32 v66, v66
    s_nop 0
    v_add_f32 v66, 1.0, v66
    v_rcp_f32 v66, v66
    s_nop 0
    v_mul_f32 v64, v64, v66
    v_and_b32 v65, 0xffff0000, v21
    v_sub_f32 v65, v65, v44
    v_fma_f32 v65, v65, v45, v46
    v_mul_f32 v67, v65, v65
    v_fma_f32 v67, v67, v14, 1.0
    v_mul_f32 v67, v67, v65
    v_mul_f32 v67, v67, v15
    v_exp_f32 v67, v67
    s_nop 0
    v_add_f32 v67, 1.0, v67
    v_rcp_f32 v67, v67
    s_nop 0
    v_mul_f32 v65, v65, v67
    v_cvt_pk_bf16_f32 v21, v64, v65
    v_lshlrev_b32 v64, 16, v22
    v_sub_f32 v64, v64, v48
    v_fma_f32 v64, v64, v49, v50
    v_mul_f32 v66, v64, v64
    v_fma_f32 v66, v66, v14, 1.0
    v_mul_f32 v66, v66, v64
    v_mul_f32 v66, v66, v15
    v_exp_f32 v66, v66
    s_nop 0
    v_add_f32 v66, 1.0, v66
    v_rcp_f32 v66, v66
    s_nop 0
    v_mul_f32 v64, v64, v66
    v_and_b32 v65, 0xffff0000, v22
    v_sub_f32 v65, v65, v52
    v_fma_f32 v65, v65, v53, v54
    v_mul_f32 v67, v65, v65
    v_fma_f32 v67, v67, v14, 1.0
    v_mul_f32 v67, v67, v65
    v_mul_f32 v67, v67, v15
    v_exp_f32 v67, v67
    s_nop 0
    v_add_f32 v67, 1.0, v67
    v_rcp_f32 v67, v67
    s_nop 0
    v_mul_f32 v65, v65, v67
    v_cvt_pk_bf16_f32 v22, v64, v65
    v_lshlrev_b32 v64, 16, v23
    v_sub_f32 v64, v64, v56
    v_fma_f32 v64, v64, v57, v58
    v_mul_f32 v66, v64, v64
    v_fma_f32 v66, v66, v14, 1.0
    v_mul_f32 v66, v66, v64
    v_mul_f32 v66, v66, v15
    v_exp_f32 v66, v66
    s_nop 0
    v_add_f32 v66, 1.0, v66
    v_rcp_f32 v66, v66
    s_nop 0
    v_mul_f32 v64, v64, v66
    v_and_b32 v65, 0xffff0000, v23
    v_sub_f32 v65, v65, v60
    v_fma_f32 v65, v65, v61, v62
    v_mul_f32 v67, v65, v65
    v_fma_f32 v67, v67, v14, 1.0
    v_mul_f32 v67, v67, v65
    v_mul_f32 v67, v67, v15
    v_exp_f32 v67, v67
    s_nop 0
    v_add_f32 v67, 1.0, v67
    v_rcp_f32 v67, v67
    s_nop 0
    v_mul_f32 v65, v65, v67
    v_cvt_pk_bf16_f32 v23, v64, v65
    v_cmp_gt_i32 vcc, 1967, v13
    s_and_saveexec_b64 s[44:45], vcc
    buffer_store_dwordx4 v[20:23], v5, s[8:11], 0 offen
    s_mov_b64 exec, s[44:45]
    v_add_u32 v5, 65536, v4
    v_lshlrev_b32 v64, 16, v24
    v_sub_f32 v64, v64, v32
    v_fma_f32 v64, v64, v33, v34
    v_mul_f32 v66, v64, v64
    v_fma_f32 v66, v66, v14, 1.0
    v_mul_f32 v66, v66, v64
    v_mul_f32 v66, v66, v15
    v_exp_f32 v66, v66
    s_nop 0
    v_add_f32 v66, 1.0, v66
    v_rcp_f32 v66, v66
    s_nop 0
    v_mul_f32 v64, v64, v66
    v_and_b32 v65, 0xffff0000, v24
    v_sub_f32 v65, v65, v36
    v_fma_f32 v65, v65, v37, v38
    v_mul_f32 v67, v65, v65
    v_fma_f32 v67, v67, v14, 1.0
    v_mul_f32 v67, v67, v65
    v_mul_f32 v67, v67, v15
    v_exp_f32 v67, v67
    s_nop 0
    v_add_f32 v67, 1.0, v67
    v_rcp_f32 v67, v67
    s_nop 0
    v_mul_f32 v65, v65, v67
    v_cvt_pk_bf16_f32 v24, v64, v65
    v_lshlrev_b32 v64, 16, v25
    v_sub_f32 v64, v64, v40
    v_fma_f32 v64, v64, v41, v42
    v_mul_f32 v66, v64, v64
    v_fma_f32 v66, v66, v14, 1.0
    v_mul_f32 v66, v66, v64
    v_mul_f32 v66, v66, v15
    v_exp_f32 v66, v66
    s_nop 0
    v_add_f32 v66, 1.0, v66
    v_rcp_f32 v66, v66
    s_nop 0
    v_mul_f32 v64, v64, v66
    v_and_b32 v65, 0xffff0000, v25
    v_sub_f32 v65, v65, v44
    v_fma_f32 v65, v65, v45, v46
    v_mul_f32 v67, v65, v65
    v_fma_f32 v67, v67, v14, 1.0
    v_mul_f32 v67, v67, v65
    v_mul_f32 v67, v67, v15
    v_exp_f32 v67, v67
    s_nop 0
    v_add_f32 v67, 1.0, v67
    v_rcp_f32 v67, v67
    s_nop 0
    v_mul_f32 v65, v65, v67
    v_cvt_pk_bf16_f32 v25, v64, v65
    v_lshlrev_b32 v64, 16, v26
    v_sub_f32 v64, v64, v48
    v_fma_f32 v64, v64, v49, v50
    v_mul_f32 v66, v64, v64
    v_fma_f32 v66, v66, v14, 1.0
    v_mul_f32 v66, v66, v64
    v_mul_f32 v66, v66, v15
    v_exp_f32 v66, v66
    s_nop 0
    v_add_f32 v66, 1.0, v66
    v_rcp_f32 v66, v66
    s_nop 0
    v_mul_f32 v64, v64, v66
    v_and_b32 v65, 0xffff0000, v26
    v_sub_f32 v65, v65, v52
    v_fma_f32 v65, v65, v53, v54
    v_mul_f32 v67, v65, v65
    v_fma_f32 v67, v67, v14, 1.0
    v_mul_f32 v67, v67, v65
    v_mul_f32 v67, v67, v15
    v_exp_f32 v67, v67
    s_nop 0
    v_add_f32 v67, 1.0, v67
    v_rcp_f32 v67, v67
    s_nop 0
    v_mul_f32 v65, v65, v67
    v_cvt_pk_bf16_f32 v26, v64, v65
    v_lshlrev_b32 v64, 16, v27
    v_sub_f32 v64, v64, v56
    v_fma_f32 v64, v64, v57, v58
    v_mul_f32 v66, v64, v64
    v_fma_f32 v66, v66, v14, 1.0
    v_mul_f32 v66, v66, v64
    v_mul_f32 v66, v66, v15
    v_exp_f32 v66, v66
    s_nop 0
    v_add_f32 v66, 1.0, v66
    v_rcp_f32 v66, v66
    s_nop 0
    v_mul_f32 v64, v64, v66
    v_and_b32 v65, 0xffff0000, v27
    v_sub_f32 v65, v65, v60
    v_fma_f32 v65, v65, v61, v62
    v_mul_f32 v67, v65, v65
    v_fma_f32 v67, v67, v14, 1.0
    v_mul_f32 v67, v67, v65
    v_mul_f32 v67, v67, v15
    v_exp_f32 v67, v67
    s_nop 0
    v_add_f32 v67, 1.0, v67
    v_rcp_f32 v67, v67
    s_nop 0
    v_mul_f32 v65, v65, v67
    v_cvt_pk_bf16_f32 v27, v64, v65
    v_cmp_gt_i32 vcc, 1935, v13
    s_and_saveexec_b64 s[44:45], vcc
    buffer_store_dwordx4 v[24:27], v5, s[8:11], 0 offen
    s_mov_b64 exec, s[44:45]
    v_add_u32 v5, 98304, v4
    v_lshlrev_b32 v64, 16, v28
    v_sub_f32 v64, v64, v32
    v_fma_f32 v64, v64, v33, v34
    v_mul_f32 v66, v64, v64
    v_fma_f32 v66, v66, v14, 1.0
    v_mul_f32 v66, v66, v64
    v_mul_f32 v66, v66, v15
    v_exp_f32 v66, v66
    s_nop 0
    v_add_f32 v66, 1.0, v66
    v_rcp_f32 v66, v66
    s_nop 0
    v_mul_f32 v64, v64, v66
    v_and_b32 v65, 0xffff0000, v28
    v_sub_f32 v65, v65, v36
    v_fma_f32 v65, v65, v37, v38
    v_mul_f32 v67, v65, v65
    v_fma_f32 v67, v67, v14, 1.0
    v_mul_f32 v67, v67, v65
    v_mul_f32 v67, v67, v15
    v_exp_f32 v67, v67
    s_nop 0
    v_add_f32 v67, 1.0, v67
    v_rcp_f32 v67, v67
    s_nop 0
    v_mul_f32 v65, v65, v67
    v_cvt_pk_bf16_f32 v28, v64, v65
    v_lshlrev_b32 v64, 16, v29
    v_sub_f32 v64, v64, v40
    v_fma_f32 v64, v64, v41, v42
    v_mul_f32 v66, v64, v64
    v_fma_f32 v66, v66, v14, 1.0
    v_mul_f32 v66, v66, v64
    v_mul_f32 v66, v66, v15
    v_exp_f32 v66, v66
    s_nop 0
    v_add_f32 v66, 1.0, v66
    v_rcp_f32 v66, v66
    s_nop 0
    v_mul_f32 v64, v64, v66
    v_and_b32 v65, 0xffff0000, v29
    v_sub_f32 v65, v65, v44
    v_fma_f32 v65, v65, v45, v46
    v_mul_f32 v67, v65, v65
    v_fma_f32 v67, v67, v14, 1.0
    v_mul_f32 v67, v67, v65
    v_mul_f32 v67, v67, v15
    v_exp_f32 v67, v67
    s_nop 0
    v_add_f32 v67, 1.0, v67
    v_rcp_f32 v67, v67
    s_nop 0
    v_mul_f32 v65, v65, v67
    v_cvt_pk_bf16_f32 v29, v64, v65
    v_lshlrev_b32 v64, 16, v30
    v_sub_f32 v64, v64, v48
    v_fma_f32 v64, v64, v49, v50
    v_mul_f32 v66, v64, v64
    v_fma_f32 v66, v66, v14, 1.0
    v_mul_f32 v66, v66, v64
    v_mul_f32 v66, v66, v15
    v_exp_f32 v66, v66
    s_nop 0
    v_add_f32 v66, 1.0, v66
    v_rcp_f32 v66, v66
    s_nop 0
    v_mul_f32 v64, v64, v66
    v_and_b32 v65, 0xffff0000, v30
    v_sub_f32 v65, v65, v52
    v_fma_f32 v65, v65, v53, v54
    v_mul_f32 v67, v65, v65
    v_fma_f32 v67, v67, v14, 1.0
    v_mul_f32 v67, v67, v65
    v_mul_f32 v67, v67, v15
    v_exp_f32 v67, v67
    s_nop 0
    v_add_f32 v67, 1.0, v67
    v_rcp_f32 v67, v67
    s_nop 0
    v_mul_f32 v65, v65, v67
    v_cvt_pk_bf16_f32 v30, v64, v65
    v_lshlrev_b32 v64, 16, v31
    v_sub_f32 v64, v64, v56
    v_fma_f32 v64, v64, v57, v58
    v_mul_f32 v66, v64, v64
    v_fma_f32 v66, v66, v14, 1.0
    v_mul_f32 v66, v66, v64
    v_mul_f32 v66, v66, v15
    v_exp_f32 v66, v66
    s_nop 0
    v_add_f32 v66, 1.0, v66
    v_rcp_f32 v66, v66
    s_nop 0
    v_mul_f32 v64, v64, v66
    v_and_b32 v65, 0xffff0000, v31
    v_sub_f32 v65, v65, v60
    v_fma_f32 v65, v65, v61, v62
    v_mul_f32 v67, v65, v65
    v_fma_f32 v67, v67, v14, 1.0
    v_mul_f32 v67, v67, v65
    v_mul_f32 v67, v67, v15
    v_exp_f32 v67, v67
    s_nop 0
    v_add_f32 v67, 1.0, v67
    v_rcp_f32 v67, v67
    s_nop 0
    v_mul_f32 v65, v65, v67
    v_cvt_pk_bf16_f32 v31, v64, v65
    v_cmp_gt_i32 vcc, 1903, v13
    s_and_saveexec_b64 s[44:45], vcc
    buffer_store_dwordx4 v[28:31], v5, s[8:11], 0 offen
    s_mov_b64 exec, s[44:45]
L_k2_end:
    s_endpgm
.section .rodata,"a"
.p2align 6
.amdhsa_kernel conv_gemm_kernel
  .amdhsa_next_free_vgpr 96
  .amdhsa_next_free_sgpr 48
  .amdhsa_accum_offset 96
  .amdhsa_group_segment_fixed_size 0
  .amdhsa_kernarg_size 64
  .amdhsa_user_sgpr_count 2
  .amdhsa_user_sgpr_kernarg_segment_ptr 1
  .amdhsa_system_sgpr_workgroup_id_x 1
.end_amdhsa_kernel
.p2align 6
.amdhsa_kernel norm_gelu_kernel
  .amdhsa_next_free_vgpr 72
  .amdhsa_next_free_sgpr 48
  .amdhsa_accum_offset 72
  .amdhsa_group_segment_fixed_size 0
  .amdhsa_kernarg_size 64
  .amdhsa_user_sgpr_count 2
  .amdhsa_user_sgpr_kernarg_segment_ptr 1
  .amdhsa_system_sgpr_workgroup_id_x 1
.end_amdhsa_kernel
```
